```python
import torch

def _softmax(x, axis=-1):
    return torch.softmax(x, dim=axis)
def _gelu(x):
    return torch.nn.functional.gelu(x, approximate="tanh")
def _silu(x):
    return torch.nn.functional.silu(x)
def _sigmoid(x):
    return torch.sigmoid(x)
def _layernorm(x, axis=-1, eps=1e-5):
    m = x.mean(dim=axis, keepdim=True)
    v = x.var(dim=axis, keepdim=True, unbiased=False)
    return (x - m) / torch.sqrt(v + eps)
def _scatter_add(tgt, idx, src, axis=0):
    return tgt.clone().index_add_(axis, idx, src)
def _segment_sum(src, seg, n):
    out = torch.zeros((n,) + src.shape[1:], dtype=src.dtype)
    return out.index_add_(0, seg, src)
def _pad(x, pw):
    flat = tuple(v for pair in reversed(pw) for v in pair)
    return torch.nn.functional.pad(x, flat)

kernel_name = 'parallel_sum__ssm_conv_s4__swiglu_ffn__prompt'

def setup_inputs():

    _w = (lambda a: (lambda t: t.to(torch.bfloat16) if t.is_floating_point() else t)(torch.as_tensor(a)))
    def _A_setup():
        B, L, D, N = 1, 2048, 640, 192
        A_re = -(lambda _x: torch.exp(torch.as_tensor(_x)))((lambda *s: torch.randn(*s, dtype=torch.bfloat16) * 3.2)(D, N))
        A_im = torch.pi * (lambda *s: torch.randn(*s, dtype=torch.bfloat16) * 0.2)(D, N)
        B_re = (lambda *s: torch.randn(*s, dtype=torch.bfloat16) * 0.4)(D, N)
        B_im = (lambda *s: torch.randn(*s, dtype=torch.bfloat16) * 0.4)(D, N)
        C_re = (lambda *s: torch.randn(*s, dtype=torch.bfloat16) * 0.4)(D, N)
        C_im = (lambda *s: torch.randn(*s, dtype=torch.bfloat16) * 0.4)(D, N)
        log_dt = (lambda *s: torch.randn(*s, dtype=torch.bfloat16) * 0.2)(D) * 0.5 - 4.0
        Dskip = (lambda *s: torch.randn(*s, dtype=torch.bfloat16) * 0.4)(D)
        return {
            "u": _w((lambda *s: torch.randn(*s, dtype=torch.bfloat16) * 0.05)(B, L, D)),
            "A_re": _w(A_re),
            "A_im": _w(A_im),
            "B_re": _w(B_re),
            "B_im": _w(B_im),
            "C_re": _w(C_re),
            "C_im": _w(C_im),
            "log_dt": _w(log_dt),
            "Dskip": _w(Dskip),
        }
    _A_in = _A_setup()

    def _B_setup():
        B, S, D, F = 1, 2048, 640, 1536
        return {
            "x": _w((lambda *s: torch.randn(*s, dtype=torch.bfloat16) * 0.05)(B, S, D)),
            "w_gate": _w((lambda *s: torch.randn(*s, dtype=torch.bfloat16) * 0.05)(D, F)),
            "w_up": _w((lambda *s: torch.randn(*s, dtype=torch.bfloat16) * 0.05)(D, F)),
            "w_down": _w((lambda *s: torch.randn(*s, dtype=torch.bfloat16) * 0.05)(F, D)),
        }
    _B_in = _B_setup()

    return {
        "A_u": _A_in["u"],
        "A_A_re": _A_in["A_re"],
        "A_A_im": _A_in["A_im"],
        "A_B_re": _A_in["B_re"],
        "A_B_im": _A_in["B_im"],
        "A_C_re": _A_in["C_re"],
        "A_C_im": _A_in["C_im"],
        "A_log_dt": _A_in["log_dt"],
        "A_Dskip": _A_in["Dskip"],
        "B_x": _B_in["x"],
        "B_w_gate": _B_in["w_gate"],
        "B_w_up": _B_in["w_up"],
        "B_w_down": _B_in["w_down"],
    }

def reference(A_u, A_A_re, A_A_im, A_B_re, A_B_im, A_C_re, A_C_im, A_log_dt, A_Dskip, B_x, B_w_gate, B_w_up, B_w_down):
    def _A_ref(u, A_re, A_im, B_re, B_im, C_re, C_im, log_dt, Dskip):
        Bsz, L, D = u.shape
        dt = torch.exp(log_dt)[:, None]
        A = A_re + 1j * A_im
        Bc = B_re + 1j * B_im
        Cc = C_re + 1j * C_im
        logdA = dt * A
        dB = dt * Bc
        l = (lambda x, dt: x.to(dt))(torch.arange(L), A_re.dtype)
        P = torch.exp(logdA[:, :, None] * l[None, None, :])
        K = torch.einsum("dn,dnl,dn->dl", Cc, P, dB).real
        L2 = 2 * L
        Kp = _pad(K, ((0, 0), (0, L)))
        up = (lambda x, *d: x.permute(*d))(u, 0, 2, 1)
        up = _pad(up, ((0, 0), (0, 0), (0, L)))
        Kf = (lambda x, axes=(-2,-1): torch.fft.rfft2(x.float(), dim=axes))(Kp[:, None, :], axes=(-2, -1))
        Uf = (lambda x, axes=(-2,-1): torch.fft.rfft2(x.float(), dim=axes))(up[:, :, None, :], axes=(-2, -1))
        Yf = Uf * Kf[None, :, :, :]
        y = (lambda x, s, axes=(-2,-1): torch.fft.irfft2(x, s=s, dim=axes).to(torch.bfloat16))(Yf, (1, L2), axes=(-2, -1))[:, :, 0, :L]
        y = (lambda x, *d: x.permute(*d))(y, 0, 2, 1) + u * Dskip[None, None, :]
        return y

    def _B_ref(x, w_gate, w_up, w_down):
        g = _silu(x @ w_gate)
        u = x @ w_up
        return (g * u) @ w_down

    x = A_u
    xn = _layernorm(x, axis=-1)
    return x + _A_ref(xn, A_A_re, A_A_im, A_B_re, A_B_im, A_C_re, A_C_im, A_log_dt, A_Dskip) + _B_ref(xn, B_w_gate, B_w_up, B_w_down)
```

```asm
; @launch kernel=parallel_sum__ssm_conv_s4__swiglu_ffn__prompt_kernel grid=(512,1,1) block=(256,1,1) lds=81920
.amdgcn_target "amdgcn-amd-amdhsa--gfx950"
.text
.globl parallel_sum__ssm_conv_s4__swiglu_ffn__prompt_kernel
.p2align 8
.type parallel_sum__ssm_conv_s4__swiglu_ffn__prompt_kernel,@function
parallel_sum__ssm_conv_s4__swiglu_ffn__prompt_kernel:

s_cmp_ge_u32 s2, 64
s_cbranch_scc1 L_nopf
s_getpc_b64 s[4:5]
L_pc:
v_lshlrev_b32 v2, 7, v0
v_min_u32 v2, L_code_end-L_pc-4, v2
v_mov_b32 v3, s5
v_add_co_u32 v2, vcc, s4, v2
s_nop 1
v_addc_co_u32 v3, vcc, 0, v3, vcc
global_load_dword v254, v[2:3], off
L_nopf:
v_lshrrev_b32 v1, 6, v0
v_and_b32 v0, 63, v0
v_readfirstlane_b32 s24, v1
s_cmp_lt_u32 s2, 256
s_cbranch_scc1 L_help
s_cmp_ge_u32 s2, 512
s_cbranch_scc1 L_end
s_load_dwordx2 s[4:5], s[0:1], 0
s_load_dwordx4 s[8:11], s[0:1], 80
s_load_dwordx4 s[52:55], s[0:1], 96
s_load_dwordx4 s[44:47], s[0:1], 112
s_sub_u32 s3, s2, 256
s_and_b32 s25, s3, 7
s_lshr_b32 s26, s3, 3
s_and_b32 s27, s25, 1
s_lshl_b32 s27, s27, 3
s_and_b32 s28, s26, 7
s_add_u32 s27, s27, s28
s_lshr_b32 s28, s25, 1
s_lshl_b32 s28, s28, 2
s_lshr_b32 s29, s26, 3
s_add_u32 s28, s28, s29
s_and_b32 s30, s24, 1
s_lshr_b32 s31, s24, 1
s_and_b32 s32, s26, 7
s_mul_i32 s32, s32, 20
s_lshr_b32 s32, s32, 2
s_mul_i32 s33, s29, 20
s_lshr_b32 s33, s33, 2
s_add_u32 s32, s32, s33
s_mul_i32 s33, s32, 205
s_lshr_b32 s33, s33, 11
s_mul_i32 s33, s33, 10
s_sub_u32 s32, s32, s33
v_lshrrev_b32 v14, 3, v0
s_lshl_b32 s33, s27, 7
s_lshl_b32 s34, s24, 5
s_add_u32 s33, s33, s34
v_add_u32 v14, s33, v14
v_mul_u32_u24 v14, 1280, v14
v_lshrrev_b32 v15, 4, v0
v_and_b32 v16, 7, v0
v_xor_b32 v15, v15, v16
v_lshl_add_u32 v2, v15, 4, v14
v_xor_b32 v3, 64, v2
v_add_u32 v3, 10240, v3
v_add_u32 v4, 20480, v2
v_add_u32 v5, 20480, v3
s_mul_i32 s33, s28, 192
s_mul_i32 s34, s30, 49152
s_add_u32 s33, s33, s34
v_add_u32 v14, 0, v0
v_mul_u32_u24 v15, 5462, v14
v_lshrrev_b32 v15, 16, v15
v_mul_u32_u24 v16, 12, v15
v_sub_u32 v16, v14, v16
v_lshrrev_b32 v17, 2, v15
v_and_b32 v17, 2, v17
v_xor_b32 v16, v17, v16
v_mul_u32_u24 v15, 3072, v15
v_lshl_add_u32 v15, v16, 4, v15
v_add_u32 v6, s33, v15
v_add_u32 v14, 64, v0
v_mul_u32_u24 v15, 5462, v14
v_lshrrev_b32 v15, 16, v15
v_mul_u32_u24 v16, 12, v15
v_sub_u32 v16, v14, v16
v_lshrrev_b32 v17, 2, v15
v_and_b32 v17, 2, v17
v_xor_b32 v16, v17, v16
v_mul_u32_u24 v15, 3072, v15
v_lshl_add_u32 v15, v16, 4, v15
v_add_u32 v7, s33, v15
v_add_u32 v14, 128, v0
v_mul_u32_u24 v15, 5462, v14
v_lshrrev_b32 v15, 16, v15
v_mul_u32_u24 v16, 12, v15
v_sub_u32 v16, v14, v16
v_lshrrev_b32 v17, 2, v15
v_and_b32 v17, 2, v17
v_xor_b32 v16, v17, v16
v_mul_u32_u24 v15, 3072, v15
v_lshl_add_u32 v15, v16, 4, v15
v_add_u32 v8, s33, v15
s_lshl_b32 s36, s24, 12
s_add_u32 s36, s36, 24576
s_mul_i32 s37, s24, 3072
s_lshl_b32 s38, s32, 7
s_mul_i32 s39, s32, 196608
s_waitcnt lgkmcnt(0)
s_cmp_eq_u32 s31, 0
s_cselect_b32 s16, s8, s10
s_cselect_b32 s17, s9, s11
s_mov_b32 s18, 1966080
s_mov_b32 s19, 0x20000
s_mov_b32 s12, s4
s_mov_b32 s13, s5
s_mov_b32 s14, 2621440
s_mov_b32 s15, 0x20000
s_add_u32 m0, s37, 0
s_nop 0
buffer_load_dwordx4 v6, s[16:19], s39 offen  lds
s_add_u32 m0, s37, 1024
s_nop 0
buffer_load_dwordx4 v7, s[16:19], s39 offen  lds
s_add_u32 m0, s37, 2048
s_nop 0
buffer_load_dwordx4 v8, s[16:19], s39 offen  lds
s_add_u32 s39, s39, 98304
s_cmp_eq_u32 s39, 1966080
s_cselect_b32 s39, 0, s39
s_mov_b32 s20, s46
s_mov_b32 s21, s47
s_mov_b32 s22, 33554432
s_mov_b32 s23, 0x20000
s_mov_b32 s48, s44
s_mov_b32 s49, s45
s_mov_b32 s50, 256
s_mov_b32 s51, 0x20000
s_mov_b32 s56, s54
s_mov_b32 s57, s55
s_mov_b32 s58, 2621440
s_mov_b32 s59, 0x20000
v_and_b32 v14, 15, v0
v_lshrrev_b32 v15, 4, v0
v_lshrrev_b32 v16, 1, v14
v_xor_b32 v16, v16, v15
s_lshl_b32 s33, s30, 13
s_add_u32 s33, s33, 24576
v_lshl_add_u32 v17, v14, 7, s33
v_lshl_add_u32 v9, v16, 4, v17
v_xor_b32 v10, 64, v9
v_lshrrev_b32 v16, 2, v0
v_and_b32 v16, 3, v16
v_lshl_add_u32 v16, v15, 3, v16
v_mul_u32_u24 v16, 192, v16
v_and_b32 v17, 3, v0
v_lshl_add_u32 v16, v17, 3, v16
v_and_b32 v17, 1, v15
s_mul_i32 s33, s31, 3
s_lshl_b32 s34, s30, 1
s_add_u32 s40, s33, s34
s_add_u32 s41, s33, 1
s_add_u32 s43, s33, 2
s_sub_u32 s43, s43, s34
v_xor_b32 v18, s40, v17
v_lshl_add_u32 v11, v18, 5, v16
v_xor_b32 v18, s41, v17
v_lshl_add_u32 v12, v18, 5, v16
v_xor_b32 v18, s43, v17
v_lshl_add_u32 v13, v18, 5, v16
v_mov_b64 v[128:129], 0
v_mov_b64 v[130:131], 0
v_mov_b64 v[132:133], 0
v_mov_b64 v[134:135], 0
v_mov_b64 v[136:137], 0
v_mov_b64 v[138:139], 0
v_mov_b64 v[140:141], 0
v_mov_b64 v[142:143], 0
v_mov_b64 v[144:145], 0
v_mov_b64 v[146:147], 0
v_mov_b64 v[148:149], 0
v_mov_b64 v[150:151], 0
v_mov_b64 v[152:153], 0
v_mov_b64 v[154:155], 0
v_mov_b64 v[156:157], 0
v_mov_b64 v[158:159], 0
v_mov_b64 v[160:161], 0
v_mov_b64 v[162:163], 0
v_mov_b64 v[164:165], 0
v_mov_b64 v[166:167], 0
v_mov_b64 v[168:169], 0
v_mov_b64 v[170:171], 0
v_mov_b64 v[172:173], 0
v_mov_b64 v[174:175], 0
v_mov_b64 v[176:177], 0
v_mov_b64 v[178:179], 0
v_mov_b64 v[180:181], 0
v_mov_b64 v[182:183], 0
v_mov_b64 v[184:185], 0
v_mov_b64 v[186:187], 0
v_mov_b64 v[188:189], 0
v_mov_b64 v[190:191], 0
v_mov_b64 v[192:193], 0
v_mov_b64 v[194:195], 0
v_mov_b64 v[196:197], 0
v_mov_b64 v[198:199], 0
v_mov_b64 v[200:201], 0
v_mov_b64 v[202:203], 0
v_mov_b64 v[204:205], 0
v_mov_b64 v[206:207], 0
v_mov_b64 v[208:209], 0
v_mov_b64 v[210:211], 0
v_mov_b64 v[212:213], 0
v_mov_b64 v[214:215], 0
v_mov_b64 v[216:217], 0
v_mov_b64 v[218:219], 0
v_mov_b64 v[220:221], 0
v_mov_b64 v[222:223], 0
v_mov_b64 v[104:105], 0
v_mov_b64 v[106:107], 0
v_mov_b64 v[108:109], 0
v_mov_b64 v[110:111], 0
v_mov_b64 v[112:113], 0
v_mov_b64 v[114:115], 0
v_mov_b64 v[116:117], 0
v_mov_b64 v[118:119], 0
v_mov_b32 v20, 0x3f803f80
v_mov_b32 v21, 0x3f803f80
v_mov_b32 v22, 0x3f803f80
v_mov_b32 v23, 0x3f803f80
v_lshlrev_b32 v1, 4, v0
s_lshr_b32 s60, s25, 1
s_lshl_b32 s60, s60, 3
s_and_b32 s33, s26, 7
s_add_u32 s60, s60, s33
s_and_b32 s61, s25, 1
s_lshl_b32 s61, s61, 2
s_lshr_b32 s33, s26, 3
s_add_u32 s61, s61, s33
s_and_b32 s62, s26, 7
s_mul_i32 s62, s62, 0
s_lshr_b32 s62, s62, 2
s_mul_i32 s33, s29, 0
s_lshr_b32 s33, s33, 2
s_add_u32 s62, s62, s33
s_mul_i32 s33, s62, 171
s_lshr_b32 s33, s33, 11
s_mul_i32 s33, s33, 12
s_sub_u32 s62, s62, s33
s_mul_i32 s63, s60, 196608
s_mul_i32 s33, s24, 12288
s_add_u32 s63, s63, s33
s_mul_i32 s64, s61, 245760
s_mul_i32 s33, s24, 61440
s_add_u32 s64, s64, s33
s_add_u32 s64, s64, 6291456
s_lshl_b32 s66, s62, 10
s_add_u32 s66, s66, s63
s_mul_i32 s78, s62, 5120
s_add_u32 s78, s78, s64
s_add_u32 s62, s62, 1
s_cmp_eq_u32 s62, 12
s_cselect_b32 s62, 0, s62
s_lshl_b32 s67, s62, 10
s_add_u32 s67, s67, s63
s_mul_i32 s79, s62, 5120
s_add_u32 s79, s79, s64
s_add_u32 s62, s62, 1
s_cmp_eq_u32 s62, 12
s_cselect_b32 s62, 0, s62
s_lshl_b32 s68, s62, 10
s_add_u32 s68, s68, s63
s_mul_i32 s80, s62, 5120
s_add_u32 s80, s80, s64
s_add_u32 s62, s62, 1
s_cmp_eq_u32 s62, 12
s_cselect_b32 s62, 0, s62
s_lshl_b32 s69, s62, 10
s_add_u32 s69, s69, s63
s_mul_i32 s81, s62, 5120
s_add_u32 s81, s81, s64
s_add_u32 s62, s62, 1
s_cmp_eq_u32 s62, 12
s_cselect_b32 s62, 0, s62
s_lshl_b32 s70, s62, 10
s_add_u32 s70, s70, s63
s_mul_i32 s82, s62, 5120
s_add_u32 s82, s82, s64
s_add_u32 s62, s62, 1
s_cmp_eq_u32 s62, 12
s_cselect_b32 s62, 0, s62
s_lshl_b32 s71, s62, 10
s_add_u32 s71, s71, s63
s_mul_i32 s83, s62, 5120
s_add_u32 s83, s83, s64
s_add_u32 s62, s62, 1
s_cmp_eq_u32 s62, 12
s_cselect_b32 s62, 0, s62
s_lshl_b32 s72, s62, 10
s_add_u32 s72, s72, s63
s_mul_i32 s84, s62, 5120
s_add_u32 s84, s84, s64
s_add_u32 s62, s62, 1
s_cmp_eq_u32 s62, 12
s_cselect_b32 s62, 0, s62
s_lshl_b32 s73, s62, 10
s_add_u32 s73, s73, s63
s_mul_i32 s85, s62, 5120
s_add_u32 s85, s85, s64
s_add_u32 s62, s62, 1
s_cmp_eq_u32 s62, 12
s_cselect_b32 s62, 0, s62
s_lshl_b32 s74, s62, 10
s_add_u32 s74, s74, s63
s_mul_i32 s86, s62, 5120
s_add_u32 s86, s86, s64
s_add_u32 s62, s62, 1
s_cmp_eq_u32 s62, 12
s_cselect_b32 s62, 0, s62
s_lshl_b32 s75, s62, 10
s_add_u32 s75, s75, s63
s_mul_i32 s87, s62, 5120
s_add_u32 s87, s87, s64
s_add_u32 s62, s62, 1
s_cmp_eq_u32 s62, 12
s_cselect_b32 s62, 0, s62
s_lshl_b32 s76, s62, 10
s_add_u32 s76, s76, s63
s_mul_i32 s88, s62, 5120
s_add_u32 s88, s88, s64
s_add_u32 s62, s62, 1
s_cmp_eq_u32 s62, 12
s_cselect_b32 s62, 0, s62
s_lshl_b32 s77, s62, 10
s_add_u32 s77, s77, s63
s_mul_i32 s89, s62, 5120
s_add_u32 s89, s89, s64
s_add_u32 s62, s62, 1
s_cmp_eq_u32 s62, 12
s_cselect_b32 s62, 0, s62
s_mul_i32 s65, s24, 5120
v_add_u32 v14, 0, v0
v_mul_u32_u24 v15, 6554, v14
v_lshrrev_b32 v15, 16, v15
v_mul_u32_u24 v15, 1120, v15
v_lshl_add_u32 v240, v14, 4, v15
v_add_u32 v14, 64, v0
v_mul_u32_u24 v15, 6554, v14
v_lshrrev_b32 v15, 16, v15
v_mul_u32_u24 v15, 1120, v15
v_lshl_add_u32 v241, v14, 4, v15
v_add_u32 v14, 128, v0
v_mul_u32_u24 v15, 6554, v14
v_lshrrev_b32 v15, 16, v15
v_mul_u32_u24 v15, 1120, v15
v_lshl_add_u32 v242, v14, 4, v15
v_add_u32 v243, 4096, v1
s_add_u32 m0, s36, 0
s_nop 0
buffer_load_dwordx4 v2, s[12:15], s38 offen  lds
s_add_u32 m0, s36, 1024
s_nop 0
buffer_load_dwordx4 v3, s[12:15], s38 offen  lds
s_add_u32 m0, s36, 2048
s_nop 0
buffer_load_dwordx4 v4, s[12:15], s38 offen  lds
s_add_u32 m0, s36, 3072
s_nop 0
buffer_load_dwordx4 v5, s[12:15], s38 offen  lds
s_add_u32 s38, s38, 128
s_cmp_eq_u32 s38, 1280
s_cselect_b32 s38, 0, s38
s_add_u32 m0, s37, 12288
s_nop 0
buffer_load_dwordx4 v6, s[16:19], s39 offen  lds
s_add_u32 m0, s37, 13312
s_nop 0
buffer_load_dwordx4 v7, s[16:19], s39 offen  lds
s_add_u32 m0, s37, 14336
s_nop 0
buffer_load_dwordx4 v8, s[16:19], s39 offen  lds
s_add_u32 s39, s39, 98304
s_cmp_eq_u32 s39, 1966080
s_cselect_b32 s39, 0, s39
s_add_u32 m0, s37, 40960
s_nop 0
buffer_load_dwordx4 v6, s[16:19], s39 offen  lds
s_add_u32 m0, s37, 41984
s_nop 0
buffer_load_dwordx4 v7, s[16:19], s39 offen  lds
s_add_u32 m0, s37, 43008
s_nop 0
buffer_load_dwordx4 v8, s[16:19], s39 offen  lds
s_add_u32 s39, s39, 98304
s_cmp_eq_u32 s39, 1966080
s_cselect_b32 s39, 0, s39
s_mov_b32 s90, 0
s_setprio 2
s_waitcnt vmcnt(6) lgkmcnt(0)
s_barrier
ds_read_b64_tr_b16 v[40:41], v11 offset:0
ds_read_b64_tr_b16 v[42:43], v11 offset:768
ds_read_b128 v[24:27], v9 offset:0
ds_read_b128 v[28:31], v9 offset:2048
ds_read_b64_tr_b16 v[44:45], v11 offset:6144
ds_read_b64_tr_b16 v[46:47], v11 offset:6912
ds_read_b128 v[32:35], v9 offset:4096
ds_read_b128 v[36:39], v9 offset:6144
ds_read_b64_tr_b16 v[48:49], v12 offset:0
ds_read_b64_tr_b16 v[50:51], v12 offset:768
ds_read_b64_tr_b16 v[52:53], v12 offset:6144
ds_read_b64_tr_b16 v[54:55], v12 offset:6912
s_waitcnt lgkmcnt(8)
ds_read_b64_tr_b16 v[56:57], v13 offset:0
ds_read_b64_tr_b16 v[58:59], v13 offset:768
ds_read_b64_tr_b16 v[60:61], v13 offset:6144
ds_read_b64_tr_b16 v[62:63], v13 offset:6912
s_add_u32 m0, s36, 40960
s_nop 0
buffer_load_dwordx4 v2, s[12:15], s38 offen  lds
s_add_u32 m0, s36, 41984
s_nop 0
buffer_load_dwordx4 v3, s[12:15], s38 offen  lds
s_add_u32 m0, s36, 43008
s_nop 0
buffer_load_dwordx4 v4, s[12:15], s38 offen  lds
s_add_u32 m0, s36, 44032
s_nop 0
buffer_load_dwordx4 v5, s[12:15], s38 offen  lds
s_add_u32 s38, s38, 128
s_cmp_eq_u32 s38, 1280
s_cselect_b32 s38, 0, s38
s_add_u32 m0, s37, 53248
s_nop 0
buffer_load_dwordx4 v6, s[16:19], s39 offen  lds
s_branch L_g1_in
L_g1_loop:
s_waitcnt vmcnt(6) lgkmcnt(0)
s_barrier
v_mfma_f32_16x16x32_bf16 v[128:131], v[80:83], v[64:67], v[128:131]
ds_read_b64_tr_b16 v[40:41], v11 offset:0
v_mfma_f32_16x16x32_bf16 v[132:135], v[80:83], v[68:71], v[132:135]
ds_read_b64_tr_b16 v[42:43], v11 offset:768
s_add_u32 m0, s36, 40960
v_mfma_f32_16x16x32_bf16 v[136:139], v[80:83], v[72:75], v[136:139]
buffer_load_dwordx4 v2, s[12:15], s38 offen  lds
v_mfma_f32_16x16x32_bf16 v[140:143], v[80:83], v[76:79], v[140:143]
ds_read_b128 v[24:27], v9 offset:0
v_mfma_f32_16x16x32_bf16 v[104:107], v[80:83], v[20:23], v[104:107]
ds_read_b128 v[28:31], v9 offset:2048
v_mfma_f32_16x16x32_bf16 v[144:147], v[84:87], v[64:67], v[144:147]
ds_read_b64_tr_b16 v[44:45], v11 offset:6144
s_add_u32 m0, s36, 41984
v_mfma_f32_16x16x32_bf16 v[148:151], v[84:87], v[68:71], v[148:151]
buffer_load_dwordx4 v3, s[12:15], s38 offen  lds
v_mfma_f32_16x16x32_bf16 v[152:155], v[84:87], v[72:75], v[152:155]
ds_read_b64_tr_b16 v[46:47], v11 offset:6912
v_mfma_f32_16x16x32_bf16 v[156:159], v[84:87], v[76:79], v[156:159]
ds_read_b128 v[32:35], v9 offset:4096
v_mfma_f32_16x16x32_bf16 v[108:111], v[84:87], v[20:23], v[108:111]
ds_read_b128 v[36:39], v9 offset:6144
v_mfma_f32_16x16x32_bf16 v[160:163], v[88:91], v[64:67], v[160:163]
ds_read_b64_tr_b16 v[48:49], v12 offset:0
s_add_u32 m0, s36, 43008
v_mfma_f32_16x16x32_bf16 v[164:167], v[88:91], v[68:71], v[164:167]
buffer_load_dwordx4 v4, s[12:15], s38 offen  lds
v_mfma_f32_16x16x32_bf16 v[168:171], v[88:91], v[72:75], v[168:171]
ds_read_b64_tr_b16 v[50:51], v12 offset:768
v_mfma_f32_16x16x32_bf16 v[172:175], v[88:91], v[76:79], v[172:175]
ds_read_b64_tr_b16 v[52:53], v12 offset:6144
v_mfma_f32_16x16x32_bf16 v[112:115], v[88:91], v[20:23], v[112:115]
ds_read_b64_tr_b16 v[54:55], v12 offset:6912
v_mfma_f32_16x16x32_bf16 v[176:179], v[92:95], v[64:67], v[176:179]
ds_read_b64_tr_b16 v[56:57], v13 offset:0
s_add_u32 m0, s36, 44032
v_mfma_f32_16x16x32_bf16 v[180:183], v[92:95], v[68:71], v[180:183]
buffer_load_dwordx4 v5, s[12:15], s38 offen  lds
v_mfma_f32_16x16x32_bf16 v[184:187], v[92:95], v[72:75], v[184:187]
ds_read_b64_tr_b16 v[58:59], v13 offset:768
s_add_u32 s38, s38, 128
v_mfma_f32_16x16x32_bf16 v[188:191], v[92:95], v[76:79], v[188:191]
ds_read_b64_tr_b16 v[60:61], v13 offset:6144
s_cmp_eq_u32 s38, 1280
v_mfma_f32_16x16x32_bf16 v[116:119], v[92:95], v[20:23], v[116:119]
ds_read_b64_tr_b16 v[62:63], v13 offset:6912
s_cselect_b32 s38, 0, s38
v_mfma_f32_16x16x32_bf16 v[192:195], v[96:99], v[64:67], v[192:195]
s_add_u32 m0, s37, 53248
v_mfma_f32_16x16x32_bf16 v[196:199], v[96:99], v[68:71], v[196:199]
buffer_load_dwordx4 v6, s[16:19], s39 offen  lds
v_mfma_f32_16x16x32_bf16 v[200:203], v[96:99], v[72:75], v[200:203]
v_mfma_f32_16x16x32_bf16 v[204:207], v[96:99], v[76:79], v[204:207]
v_mfma_f32_16x16x32_bf16 v[208:211], v[100:103], v[64:67], v[208:211]
v_mfma_f32_16x16x32_bf16 v[212:215], v[100:103], v[68:71], v[212:215]
v_mfma_f32_16x16x32_bf16 v[216:219], v[100:103], v[72:75], v[216:219]
v_mfma_f32_16x16x32_bf16 v[220:223], v[100:103], v[76:79], v[220:223]
L_g1_in:
s_waitcnt vmcnt(8) lgkmcnt(0)
s_barrier
v_mfma_f32_16x16x32_bf16 v[128:131], v[40:43], v[24:27], v[128:131]
ds_read_b64_tr_b16 v[80:81], v11 offset:12288
v_mfma_f32_16x16x32_bf16 v[132:135], v[40:43], v[28:31], v[132:135]
ds_read_b64_tr_b16 v[82:83], v11 offset:13056
s_add_u32 m0, s37, 54272
v_mfma_f32_16x16x32_bf16 v[136:139], v[40:43], v[32:35], v[136:139]
buffer_load_dwordx4 v7, s[16:19], s39 offen  lds
v_mfma_f32_16x16x32_bf16 v[140:143], v[40:43], v[36:39], v[140:143]
ds_read_b128 v[64:67], v10 offset:0
v_mfma_f32_16x16x32_bf16 v[104:107], v[40:43], v[20:23], v[104:107]
ds_read_b128 v[68:71], v10 offset:2048
v_mfma_f32_16x16x32_bf16 v[144:147], v[44:47], v[24:27], v[144:147]
ds_read_b64_tr_b16 v[84:85], v11 offset:18432
s_add_u32 m0, s37, 55296
v_mfma_f32_16x16x32_bf16 v[148:151], v[44:47], v[28:31], v[148:151]
buffer_load_dwordx4 v8, s[16:19], s39 offen  lds
v_mfma_f32_16x16x32_bf16 v[152:155], v[44:47], v[32:35], v[152:155]
ds_read_b64_tr_b16 v[86:87], v11 offset:19200
s_add_u32 s39, s39, 98304
v_mfma_f32_16x16x32_bf16 v[156:159], v[44:47], v[36:39], v[156:159]
ds_read_b128 v[72:75], v10 offset:4096
s_cmp_eq_u32 s39, 1966080
v_mfma_f32_16x16x32_bf16 v[108:111], v[44:47], v[20:23], v[108:111]
ds_read_b128 v[76:79], v10 offset:6144
s_cselect_b32 s39, 0, s39
v_mfma_f32_16x16x32_bf16 v[160:163], v[48:51], v[24:27], v[160:163]
ds_read_b64_tr_b16 v[88:89], v12 offset:12288
s_add_u32 m0, s37, 0
v_mfma_f32_16x16x32_bf16 v[164:167], v[48:51], v[28:31], v[164:167]
buffer_load_dwordx4 v6, s[16:19], s39 offen  lds
v_mfma_f32_16x16x32_bf16 v[168:171], v[48:51], v[32:35], v[168:171]
ds_read_b64_tr_b16 v[90:91], v12 offset:13056
v_mfma_f32_16x16x32_bf16 v[172:175], v[48:51], v[36:39], v[172:175]
ds_read_b64_tr_b16 v[92:93], v12 offset:18432
v_mfma_f32_16x16x32_bf16 v[112:115], v[48:51], v[20:23], v[112:115]
ds_read_b64_tr_b16 v[94:95], v12 offset:19200
v_mfma_f32_16x16x32_bf16 v[176:179], v[52:55], v[24:27], v[176:179]
ds_read_b64_tr_b16 v[96:97], v13 offset:12288
s_add_u32 m0, s37, 1024
v_mfma_f32_16x16x32_bf16 v[180:183], v[52:55], v[28:31], v[180:183]
buffer_load_dwordx4 v7, s[16:19], s39 offen  lds
v_mfma_f32_16x16x32_bf16 v[184:187], v[52:55], v[32:35], v[184:187]
ds_read_b64_tr_b16 v[98:99], v13 offset:13056
v_mfma_f32_16x16x32_bf16 v[188:191], v[52:55], v[36:39], v[188:191]
ds_read_b64_tr_b16 v[100:101], v13 offset:18432
v_mfma_f32_16x16x32_bf16 v[116:119], v[52:55], v[20:23], v[116:119]
ds_read_b64_tr_b16 v[102:103], v13 offset:19200
v_mfma_f32_16x16x32_bf16 v[192:195], v[56:59], v[24:27], v[192:195]
s_add_u32 m0, s37, 2048
v_mfma_f32_16x16x32_bf16 v[196:199], v[56:59], v[28:31], v[196:199]
buffer_load_dwordx4 v8, s[16:19], s39 offen  lds
v_mfma_f32_16x16x32_bf16 v[200:203], v[56:59], v[32:35], v[200:203]
s_add_u32 s39, s39, 98304
v_mfma_f32_16x16x32_bf16 v[204:207], v[56:59], v[36:39], v[204:207]
s_cmp_eq_u32 s39, 1966080
v_mfma_f32_16x16x32_bf16 v[208:211], v[60:63], v[24:27], v[208:211]
s_cselect_b32 s39, 0, s39
v_mfma_f32_16x16x32_bf16 v[212:215], v[60:63], v[28:31], v[212:215]
v_mfma_f32_16x16x32_bf16 v[216:219], v[60:63], v[32:35], v[216:219]
v_mfma_f32_16x16x32_bf16 v[220:223], v[60:63], v[36:39], v[220:223]
s_waitcnt vmcnt(6) lgkmcnt(0)
s_barrier
v_mfma_f32_16x16x32_bf16 v[128:131], v[80:83], v[64:67], v[128:131]
ds_read_b64_tr_b16 v[40:41], v11 offset:40960
v_mfma_f32_16x16x32_bf16 v[132:135], v[80:83], v[68:71], v[132:135]
ds_read_b64_tr_b16 v[42:43], v11 offset:41728
s_add_u32 m0, s36, 0
v_mfma_f32_16x16x32_bf16 v[136:139], v[80:83], v[72:75], v[136:139]
buffer_load_dwordx4 v2, s[12:15], s38 offen  lds
v_mfma_f32_16x16x32_bf16 v[140:143], v[80:83], v[76:79], v[140:143]
ds_read_b128 v[24:27], v9 offset:40960
v_mfma_f32_16x16x32_bf16 v[104:107], v[80:83], v[20:23], v[104:107]
ds_read_b128 v[28:31], v9 offset:43008
v_mfma_f32_16x16x32_bf16 v[144:147], v[84:87], v[64:67], v[144:147]
ds_read_b64_tr_b16 v[44:45], v11 offset:47104
s_add_u32 m0, s36, 1024
v_mfma_f32_16x16x32_bf16 v[148:151], v[84:87], v[68:71], v[148:151]
buffer_load_dwordx4 v3, s[12:15], s38 offen  lds
v_mfma_f32_16x16x32_bf16 v[152:155], v[84:87], v[72:75], v[152:155]
ds_read_b64_tr_b16 v[46:47], v11 offset:47872
v_mfma_f32_16x16x32_bf16 v[156:159], v[84:87], v[76:79], v[156:159]
ds_read_b128 v[32:35], v9 offset:45056
v_mfma_f32_16x16x32_bf16 v[108:111], v[84:87], v[20:23], v[108:111]
ds_read_b128 v[36:39], v9 offset:47104
v_mfma_f32_16x16x32_bf16 v[160:163], v[88:91], v[64:67], v[160:163]
ds_read_b64_tr_b16 v[48:49], v12 offset:40960
s_add_u32 m0, s36, 2048
v_mfma_f32_16x16x32_bf16 v[164:167], v[88:91], v[68:71], v[164:167]
buffer_load_dwordx4 v4, s[12:15], s38 offen  lds
v_mfma_f32_16x16x32_bf16 v[168:171], v[88:91], v[72:75], v[168:171]
ds_read_b64_tr_b16 v[50:51], v12 offset:41728
v_mfma_f32_16x16x32_bf16 v[172:175], v[88:91], v[76:79], v[172:175]
ds_read_b64_tr_b16 v[52:53], v12 offset:47104
v_mfma_f32_16x16x32_bf16 v[112:115], v[88:91], v[20:23], v[112:115]
ds_read_b64_tr_b16 v[54:55], v12 offset:47872
v_mfma_f32_16x16x32_bf16 v[176:179], v[92:95], v[64:67], v[176:179]
ds_read_b64_tr_b16 v[56:57], v13 offset:40960
s_add_u32 m0, s36, 3072
v_mfma_f32_16x16x32_bf16 v[180:183], v[92:95], v[68:71], v[180:183]
buffer_load_dwordx4 v5, s[12:15], s38 offen  lds
v_mfma_f32_16x16x32_bf16 v[184:187], v[92:95], v[72:75], v[184:187]
ds_read_b64_tr_b16 v[58:59], v13 offset:41728
s_add_u32 s38, s38, 128
v_mfma_f32_16x16x32_bf16 v[188:191], v[92:95], v[76:79], v[188:191]
ds_read_b64_tr_b16 v[60:61], v13 offset:47104
s_cmp_eq_u32 s38, 1280
v_mfma_f32_16x16x32_bf16 v[116:119], v[92:95], v[20:23], v[116:119]
ds_read_b64_tr_b16 v[62:63], v13 offset:47872
s_cselect_b32 s38, 0, s38
v_mfma_f32_16x16x32_bf16 v[192:195], v[96:99], v[64:67], v[192:195]
s_add_u32 m0, s37, 12288
v_mfma_f32_16x16x32_bf16 v[196:199], v[96:99], v[68:71], v[196:199]
buffer_load_dwordx4 v6, s[16:19], s39 offen  lds
v_mfma_f32_16x16x32_bf16 v[200:203], v[96:99], v[72:75], v[200:203]
v_mfma_f32_16x16x32_bf16 v[204:207], v[96:99], v[76:79], v[204:207]
v_mfma_f32_16x16x32_bf16 v[208:211], v[100:103], v[64:67], v[208:211]
v_mfma_f32_16x16x32_bf16 v[212:215], v[100:103], v[68:71], v[212:215]
v_mfma_f32_16x16x32_bf16 v[216:219], v[100:103], v[72:75], v[216:219]
v_mfma_f32_16x16x32_bf16 v[220:223], v[100:103], v[76:79], v[220:223]
s_waitcnt vmcnt(8) lgkmcnt(0)
s_barrier
v_mfma_f32_16x16x32_bf16 v[128:131], v[40:43], v[24:27], v[128:131]
ds_read_b64_tr_b16 v[80:81], v11 offset:53248
v_mfma_f32_16x16x32_bf16 v[132:135], v[40:43], v[28:31], v[132:135]
ds_read_b64_tr_b16 v[82:83], v11 offset:54016
s_add_u32 m0, s37, 13312
v_mfma_f32_16x16x32_bf16 v[136:139], v[40:43], v[32:35], v[136:139]
buffer_load_dwordx4 v7, s[16:19], s39 offen  lds
v_mfma_f32_16x16x32_bf16 v[140:143], v[40:43], v[36:39], v[140:143]
ds_read_b128 v[64:67], v10 offset:40960
v_mfma_f32_16x16x32_bf16 v[104:107], v[40:43], v[20:23], v[104:107]
ds_read_b128 v[68:71], v10 offset:43008
v_mfma_f32_16x16x32_bf16 v[144:147], v[44:47], v[24:27], v[144:147]
ds_read_b64_tr_b16 v[84:85], v11 offset:59392
s_add_u32 m0, s37, 14336
v_mfma_f32_16x16x32_bf16 v[148:151], v[44:47], v[28:31], v[148:151]
buffer_load_dwordx4 v8, s[16:19], s39 offen  lds
v_mfma_f32_16x16x32_bf16 v[152:155], v[44:47], v[32:35], v[152:155]
ds_read_b64_tr_b16 v[86:87], v11 offset:60160
s_add_u32 s39, s39, 98304
v_mfma_f32_16x16x32_bf16 v[156:159], v[44:47], v[36:39], v[156:159]
ds_read_b128 v[72:75], v10 offset:45056
s_cmp_eq_u32 s39, 1966080
v_mfma_f32_16x16x32_bf16 v[108:111], v[44:47], v[20:23], v[108:111]
ds_read_b128 v[76:79], v10 offset:47104
s_cselect_b32 s39, 0, s39
v_mfma_f32_16x16x32_bf16 v[160:163], v[48:51], v[24:27], v[160:163]
ds_read_b64_tr_b16 v[88:89], v12 offset:53248
s_add_u32 m0, s37, 40960
v_mfma_f32_16x16x32_bf16 v[164:167], v[48:51], v[28:31], v[164:167]
buffer_load_dwordx4 v6, s[16:19], s39 offen  lds
v_mfma_f32_16x16x32_bf16 v[168:171], v[48:51], v[32:35], v[168:171]
ds_read_b64_tr_b16 v[90:91], v12 offset:54016
v_mfma_f32_16x16x32_bf16 v[172:175], v[48:51], v[36:39], v[172:175]
ds_read_b64_tr_b16 v[92:93], v12 offset:59392
v_mfma_f32_16x16x32_bf16 v[112:115], v[48:51], v[20:23], v[112:115]
ds_read_b64_tr_b16 v[94:95], v12 offset:60160
v_mfma_f32_16x16x32_bf16 v[176:179], v[52:55], v[24:27], v[176:179]
ds_read_b64_tr_b16 v[96:97], v13 offset:53248
s_add_u32 m0, s37, 41984
v_mfma_f32_16x16x32_bf16 v[180:183], v[52:55], v[28:31], v[180:183]
buffer_load_dwordx4 v7, s[16:19], s39 offen  lds
v_mfma_f32_16x16x32_bf16 v[184:187], v[52:55], v[32:35], v[184:187]
ds_read_b64_tr_b16 v[98:99], v13 offset:54016
v_mfma_f32_16x16x32_bf16 v[188:191], v[52:55], v[36:39], v[188:191]
ds_read_b64_tr_b16 v[100:101], v13 offset:59392
v_mfma_f32_16x16x32_bf16 v[116:119], v[52:55], v[20:23], v[116:119]
ds_read_b64_tr_b16 v[102:103], v13 offset:60160
v_mfma_f32_16x16x32_bf16 v[192:195], v[56:59], v[24:27], v[192:195]
s_add_u32 m0, s37, 43008
v_mfma_f32_16x16x32_bf16 v[196:199], v[56:59], v[28:31], v[196:199]
buffer_load_dwordx4 v8, s[16:19], s39 offen  lds
v_mfma_f32_16x16x32_bf16 v[200:203], v[56:59], v[32:35], v[200:203]
s_add_u32 s39, s39, 98304
v_mfma_f32_16x16x32_bf16 v[204:207], v[56:59], v[36:39], v[204:207]
s_cmp_eq_u32 s39, 1966080
v_mfma_f32_16x16x32_bf16 v[208:211], v[60:63], v[24:27], v[208:211]
s_cselect_b32 s39, 0, s39
v_mfma_f32_16x16x32_bf16 v[212:215], v[60:63], v[28:31], v[212:215]
v_mfma_f32_16x16x32_bf16 v[216:219], v[60:63], v[32:35], v[216:219]
v_mfma_f32_16x16x32_bf16 v[220:223], v[60:63], v[36:39], v[220:223]
s_add_u32 s90, s90, 1
s_cmp_lt_u32 s90, 4
s_cbranch_scc1 L_g1_loop
s_waitcnt vmcnt(6) lgkmcnt(0)
s_barrier
v_mfma_f32_16x16x32_bf16 v[128:131], v[80:83], v[64:67], v[128:131]
ds_read_b64_tr_b16 v[40:41], v11 offset:0
v_mfma_f32_16x16x32_bf16 v[132:135], v[80:83], v[68:71], v[132:135]
ds_read_b64_tr_b16 v[42:43], v11 offset:768
s_add_u32 m0, s36, 40960
v_mfma_f32_16x16x32_bf16 v[136:139], v[80:83], v[72:75], v[136:139]
buffer_load_dwordx4 v2, s[12:15], s38 offen  lds
v_mfma_f32_16x16x32_bf16 v[140:143], v[80:83], v[76:79], v[140:143]
ds_read_b128 v[24:27], v9 offset:0
v_mfma_f32_16x16x32_bf16 v[104:107], v[80:83], v[20:23], v[104:107]
ds_read_b128 v[28:31], v9 offset:2048
v_mfma_f32_16x16x32_bf16 v[144:147], v[84:87], v[64:67], v[144:147]
ds_read_b64_tr_b16 v[44:45], v11 offset:6144
s_add_u32 m0, s36, 41984
v_mfma_f32_16x16x32_bf16 v[148:151], v[84:87], v[68:71], v[148:151]
buffer_load_dwordx4 v3, s[12:15], s38 offen  lds
v_mfma_f32_16x16x32_bf16 v[152:155], v[84:87], v[72:75], v[152:155]
ds_read_b64_tr_b16 v[46:47], v11 offset:6912
v_mfma_f32_16x16x32_bf16 v[156:159], v[84:87], v[76:79], v[156:159]
ds_read_b128 v[32:35], v9 offset:4096
v_mfma_f32_16x16x32_bf16 v[108:111], v[84:87], v[20:23], v[108:111]
ds_read_b128 v[36:39], v9 offset:6144
v_mfma_f32_16x16x32_bf16 v[160:163], v[88:91], v[64:67], v[160:163]
ds_read_b64_tr_b16 v[48:49], v12 offset:0
s_add_u32 m0, s36, 43008
v_mfma_f32_16x16x32_bf16 v[164:167], v[88:91], v[68:71], v[164:167]
buffer_load_dwordx4 v4, s[12:15], s38 offen  lds
v_mfma_f32_16x16x32_bf16 v[168:171], v[88:91], v[72:75], v[168:171]
ds_read_b64_tr_b16 v[50:51], v12 offset:768
v_mfma_f32_16x16x32_bf16 v[172:175], v[88:91], v[76:79], v[172:175]
ds_read_b64_tr_b16 v[52:53], v12 offset:6144
v_mfma_f32_16x16x32_bf16 v[112:115], v[88:91], v[20:23], v[112:115]
ds_read_b64_tr_b16 v[54:55], v12 offset:6912
v_mfma_f32_16x16x32_bf16 v[176:179], v[92:95], v[64:67], v[176:179]
ds_read_b64_tr_b16 v[56:57], v13 offset:0
s_add_u32 m0, s36, 44032
v_mfma_f32_16x16x32_bf16 v[180:183], v[92:95], v[68:71], v[180:183]
buffer_load_dwordx4 v5, s[12:15], s38 offen  lds
v_mfma_f32_16x16x32_bf16 v[184:187], v[92:95], v[72:75], v[184:187]
ds_read_b64_tr_b16 v[58:59], v13 offset:768
s_add_u32 s38, s38, 128
v_mfma_f32_16x16x32_bf16 v[188:191], v[92:95], v[76:79], v[188:191]
ds_read_b64_tr_b16 v[60:61], v13 offset:6144
s_cmp_eq_u32 s38, 1280
v_mfma_f32_16x16x32_bf16 v[116:119], v[92:95], v[20:23], v[116:119]
ds_read_b64_tr_b16 v[62:63], v13 offset:6912
s_cselect_b32 s38, 0, s38
v_mfma_f32_16x16x32_bf16 v[192:195], v[96:99], v[64:67], v[192:195]
s_add_u32 m0, s37, 53248
v_mfma_f32_16x16x32_bf16 v[196:199], v[96:99], v[68:71], v[196:199]
buffer_load_dwordx4 v6, s[16:19], s39 offen  lds
v_mfma_f32_16x16x32_bf16 v[200:203], v[96:99], v[72:75], v[200:203]
v_mfma_f32_16x16x32_bf16 v[204:207], v[96:99], v[76:79], v[204:207]
v_mfma_f32_16x16x32_bf16 v[208:211], v[100:103], v[64:67], v[208:211]
v_mfma_f32_16x16x32_bf16 v[212:215], v[100:103], v[68:71], v[212:215]
v_mfma_f32_16x16x32_bf16 v[216:219], v[100:103], v[72:75], v[216:219]
v_mfma_f32_16x16x32_bf16 v[220:223], v[100:103], v[76:79], v[220:223]
s_waitcnt vmcnt(8) lgkmcnt(0)
s_barrier
v_mov_b32 v15, 0
buffer_load_dword v14, v15, s[48:51], 0 offen offset:128 sc1
v_mfma_f32_16x16x32_bf16 v[128:131], v[40:43], v[24:27], v[128:131]
ds_read_b64_tr_b16 v[80:81], v11 offset:12288
v_mfma_f32_16x16x32_bf16 v[132:135], v[40:43], v[28:31], v[132:135]
ds_read_b64_tr_b16 v[82:83], v11 offset:13056
s_add_u32 m0, s37, 54272
v_mfma_f32_16x16x32_bf16 v[136:139], v[40:43], v[32:35], v[136:139]
buffer_load_dwordx4 v7, s[16:19], s39 offen  lds
v_mfma_f32_16x16x32_bf16 v[140:143], v[40:43], v[36:39], v[140:143]
ds_read_b128 v[64:67], v10 offset:0
v_mfma_f32_16x16x32_bf16 v[104:107], v[40:43], v[20:23], v[104:107]
ds_read_b128 v[68:71], v10 offset:2048
v_mfma_f32_16x16x32_bf16 v[144:147], v[44:47], v[24:27], v[144:147]
ds_read_b64_tr_b16 v[84:85], v11 offset:18432
v_mfma_f32_16x16x32_bf16 v[148:151], v[44:47], v[28:31], v[148:151]
ds_read_b64_tr_b16 v[86:87], v11 offset:19200
v_mfma_f32_16x16x32_bf16 v[152:155], v[44:47], v[32:35], v[152:155]
ds_read_b128 v[72:75], v10 offset:4096
v_mfma_f32_16x16x32_bf16 v[156:159], v[44:47], v[36:39], v[156:159]
ds_read_b128 v[76:79], v10 offset:6144
v_mfma_f32_16x16x32_bf16 v[108:111], v[44:47], v[20:23], v[108:111]
ds_read_b64_tr_b16 v[88:89], v12 offset:12288
v_mfma_f32_16x16x32_bf16 v[160:163], v[48:51], v[24:27], v[160:163]
ds_read_b64_tr_b16 v[90:91], v12 offset:13056
v_mfma_f32_16x16x32_bf16 v[164:167], v[48:51], v[28:31], v[164:167]
ds_read_b64_tr_b16 v[92:93], v12 offset:18432
v_mfma_f32_16x16x32_bf16 v[168:171], v[48:51], v[32:35], v[168:171]
ds_read_b64_tr_b16 v[94:95], v12 offset:19200
v_mfma_f32_16x16x32_bf16 v[172:175], v[48:51], v[36:39], v[172:175]
ds_read_b64_tr_b16 v[96:97], v13 offset:12288
s_add_u32 m0, s37, 55296
v_mfma_f32_16x16x32_bf16 v[112:115], v[48:51], v[20:23], v[112:115]
buffer_load_dwordx4 v8, s[16:19], s39 offen  lds
v_mfma_f32_16x16x32_bf16 v[176:179], v[52:55], v[24:27], v[176:179]
ds_read_b64_tr_b16 v[98:99], v13 offset:13056
s_add_u32 s39, s39, 98304
v_mfma_f32_16x16x32_bf16 v[180:183], v[52:55], v[28:31], v[180:183]
ds_read_b64_tr_b16 v[100:101], v13 offset:18432
s_cmp_eq_u32 s39, 1966080
v_mfma_f32_16x16x32_bf16 v[184:187], v[52:55], v[32:35], v[184:187]
ds_read_b64_tr_b16 v[102:103], v13 offset:19200
s_cselect_b32 s39, 0, s39
v_mfma_f32_16x16x32_bf16 v[188:191], v[52:55], v[36:39], v[188:191]
v_mfma_f32_16x16x32_bf16 v[116:119], v[52:55], v[20:23], v[116:119]
v_mfma_f32_16x16x32_bf16 v[192:195], v[56:59], v[24:27], v[192:195]
v_mfma_f32_16x16x32_bf16 v[196:199], v[56:59], v[28:31], v[196:199]
v_mfma_f32_16x16x32_bf16 v[200:203], v[56:59], v[32:35], v[200:203]
v_mfma_f32_16x16x32_bf16 v[204:207], v[56:59], v[36:39], v[204:207]
v_mfma_f32_16x16x32_bf16 v[208:211], v[60:63], v[24:27], v[208:211]
v_mfma_f32_16x16x32_bf16 v[212:215], v[60:63], v[28:31], v[212:215]
v_mfma_f32_16x16x32_bf16 v[216:219], v[60:63], v[32:35], v[216:219]
v_mfma_f32_16x16x32_bf16 v[220:223], v[60:63], v[36:39], v[220:223]
s_waitcnt vmcnt(2) lgkmcnt(0)
s_barrier
s_mov_b32 s42, 0
L_g1ln_p:
v_cmp_ne_u32 vcc, 1, v14
s_cbranch_vccz L_g1ln_ok
s_add_u32 s42, s42, 1
s_cmp_gt_u32 s42, 20000
s_cbranch_scc1 L_g1ln_ok
s_sleep 16
buffer_load_dword v14, v15, s[48:51], 0 offen offset:128 sc1
s_waitcnt vmcnt(0)
s_branch L_g1ln_p
L_g1ln_ok:
v_and_b32 v16, 15, v0
v_lshlrev_b32 v16, 4, v16
s_lshl_b32 s33, s27, 11
s_lshl_b32 s34, s30, 10
s_add_u32 s33, s33, s34
s_add_u32 s33, s33, 14680064
buffer_load_dwordx4 v[224:227], v16, s[20:23], s33 offen offset:0 sc1
buffer_load_dwordx4 v[228:231], v16, s[20:23], s33 offen offset:256 sc1
buffer_load_dwordx4 v[232:235], v16, s[20:23], s33 offen offset:512 sc1
buffer_load_dwordx4 v[236:239], v16, s[20:23], s33 offen offset:768 sc1
v_mfma_f32_16x16x32_bf16 v[128:131], v[80:83], v[64:67], v[128:131]
ds_read_b64_tr_b16 v[40:41], v11 offset:40960
v_mfma_f32_16x16x32_bf16 v[132:135], v[80:83], v[68:71], v[132:135]
ds_read_b64_tr_b16 v[42:43], v11 offset:41728
s_add_u32 m0, s65, 0
v_mfma_f32_16x16x32_bf16 v[136:139], v[80:83], v[72:75], v[136:139]
buffer_load_dwordx4 v1, s[20:23], s83 offen offset:0 sc1 lds
v_mfma_f32_16x16x32_bf16 v[140:143], v[80:83], v[76:79], v[140:143]
ds_read_b128 v[24:27], v9 offset:40960
v_mfma_f32_16x16x32_bf16 v[104:107], v[80:83], v[20:23], v[104:107]
ds_read_b128 v[28:31], v9 offset:43008
v_mfma_f32_16x16x32_bf16 v[144:147], v[84:87], v[64:67], v[144:147]
ds_read_b64_tr_b16 v[44:45], v11 offset:47104
s_add_u32 m0, s65, 0
v_mfma_f32_16x16x32_bf16 v[148:151], v[84:87], v[68:71], v[148:151]
buffer_load_dwordx4 v1, s[20:23], s83 offen offset:1024 sc1 lds
v_mfma_f32_16x16x32_bf16 v[152:155], v[84:87], v[72:75], v[152:155]
ds_read_b64_tr_b16 v[46:47], v11 offset:47872
v_mfma_f32_16x16x32_bf16 v[156:159], v[84:87], v[76:79], v[156:159]
ds_read_b128 v[32:35], v9 offset:45056
v_mfma_f32_16x16x32_bf16 v[108:111], v[84:87], v[20:23], v[108:111]
ds_read_b128 v[36:39], v9 offset:47104
v_mfma_f32_16x16x32_bf16 v[160:163], v[88:91], v[64:67], v[160:163]
ds_read_b64_tr_b16 v[48:49], v12 offset:40960
s_add_u32 m0, s65, 0
v_mfma_f32_16x16x32_bf16 v[164:167], v[88:91], v[68:71], v[164:167]
buffer_load_dwordx4 v1, s[20:23], s83 offen offset:2048 sc1 lds
v_mfma_f32_16x16x32_bf16 v[168:171], v[88:91], v[72:75], v[168:171]
ds_read_b64_tr_b16 v[50:51], v12 offset:41728
v_mfma_f32_16x16x32_bf16 v[172:175], v[88:91], v[76:79], v[172:175]
ds_read_b64_tr_b16 v[52:53], v12 offset:47104
v_mfma_f32_16x16x32_bf16 v[112:115], v[88:91], v[20:23], v[112:115]
ds_read_b64_tr_b16 v[54:55], v12 offset:47872
v_mfma_f32_16x16x32_bf16 v[176:179], v[92:95], v[64:67], v[176:179]
ds_read_b64_tr_b16 v[56:57], v13 offset:40960
s_add_u32 m0, s65, 0
v_mfma_f32_16x16x32_bf16 v[180:183], v[92:95], v[68:71], v[180:183]
buffer_load_dwordx4 v1, s[20:23], s83 offen offset:3072 sc1 lds
v_mfma_f32_16x16x32_bf16 v[184:187], v[92:95], v[72:75], v[184:187]
ds_read_b64_tr_b16 v[58:59], v13 offset:41728
v_mfma_f32_16x16x32_bf16 v[188:191], v[92:95], v[76:79], v[188:191]
ds_read_b64_tr_b16 v[60:61], v13 offset:47104
v_mfma_f32_16x16x32_bf16 v[116:119], v[92:95], v[20:23], v[116:119]
ds_read_b64_tr_b16 v[62:63], v13 offset:47872
v_mfma_f32_16x16x32_bf16 v[192:195], v[96:99], v[64:67], v[192:195]
s_add_u32 m0, s65, 4096
v_mfma_f32_16x16x32_bf16 v[196:199], v[96:99], v[68:71], v[196:199]
buffer_load_dwordx4 v243, s[20:23], s83 offen offset:0 sc1 lds
v_mfma_f32_16x16x32_bf16 v[200:203], v[96:99], v[72:75], v[200:203]
v_mfma_f32_16x16x32_bf16 v[204:207], v[96:99], v[76:79], v[204:207]
v_mfma_f32_16x16x32_bf16 v[208:211], v[100:103], v[64:67], v[208:211]
v_mfma_f32_16x16x32_bf16 v[212:215], v[100:103], v[68:71], v[212:215]
v_mfma_f32_16x16x32_bf16 v[216:219], v[100:103], v[72:75], v[216:219]
v_mfma_f32_16x16x32_bf16 v[220:223], v[100:103], v[76:79], v[220:223]
s_waitcnt vmcnt(9) lgkmcnt(0)
s_barrier
s_cmp_lg_u32 s24, 0
s_cbranch_scc1 L_g1_ngo
s_cmp_ge_u32 s3, 160
s_cbranch_scc1 L_g1_ngo
s_lshl_b32 s33, s3, 7
s_add_u32 s33, s33, 14897152
v_mov_b32 v17, s33
v_mov_b32 v18, 1
v_cmp_eq_u32 vcc, 0, v0
s_nop 0
s_and_saveexec_b64 s[34:35], vcc
buffer_store_dword v18, v17, s[20:23], 0 offen sc1
s_mov_b64 exec, s[34:35]
L_g1_ngo:
v_mfma_f32_16x16x32_bf16 v[128:131], v[40:43], v[24:27], v[128:131]
ds_read_b64_tr_b16 v[80:81], v11 offset:53248
v_mfma_f32_16x16x32_bf16 v[132:135], v[40:43], v[28:31], v[132:135]
ds_read_b64_tr_b16 v[82:83], v11 offset:54016
s_add_u32 m0, s65, 20480
v_mfma_f32_16x16x32_bf16 v[136:139], v[40:43], v[32:35], v[136:139]
buffer_load_dwordx4 v1, s[20:23], s85 offen offset:0 sc1 lds
v_mfma_f32_16x16x32_bf16 v[140:143], v[40:43], v[36:39], v[140:143]
ds_read_b128 v[64:67], v10 offset:40960
v_mfma_f32_16x16x32_bf16 v[104:107], v[40:43], v[20:23], v[104:107]
ds_read_b128 v[68:71], v10 offset:43008
v_mfma_f32_16x16x32_bf16 v[144:147], v[44:47], v[24:27], v[144:147]
ds_read_b64_tr_b16 v[84:85], v11 offset:59392
s_add_u32 m0, s65, 20480
v_mfma_f32_16x16x32_bf16 v[148:151], v[44:47], v[28:31], v[148:151]
buffer_load_dwordx4 v1, s[20:23], s85 offen offset:1024 sc1 lds
v_mfma_f32_16x16x32_bf16 v[152:155], v[44:47], v[32:35], v[152:155]
ds_read_b64_tr_b16 v[86:87], v11 offset:60160
v_mfma_f32_16x16x32_bf16 v[156:159], v[44:47], v[36:39], v[156:159]
ds_read_b128 v[72:75], v10 offset:45056
v_mfma_f32_16x16x32_bf16 v[108:111], v[44:47], v[20:23], v[108:111]
ds_read_b128 v[76:79], v10 offset:47104
v_mfma_f32_16x16x32_bf16 v[160:163], v[48:51], v[24:27], v[160:163]
ds_read_b64_tr_b16 v[88:89], v12 offset:53248
s_add_u32 m0, s65, 20480
v_mfma_f32_16x16x32_bf16 v[164:167], v[48:51], v[28:31], v[164:167]
buffer_load_dwordx4 v1, s[20:23], s85 offen offset:2048 sc1 lds
v_mfma_f32_16x16x32_bf16 v[168:171], v[48:51], v[32:35], v[168:171]
ds_read_b64_tr_b16 v[90:91], v12 offset:54016
v_mfma_f32_16x16x32_bf16 v[172:175], v[48:51], v[36:39], v[172:175]
ds_read_b64_tr_b16 v[92:93], v12 offset:59392
v_mfma_f32_16x16x32_bf16 v[112:115], v[48:51], v[20:23], v[112:115]
ds_read_b64_tr_b16 v[94:95], v12 offset:60160
v_mfma_f32_16x16x32_bf16 v[176:179], v[52:55], v[24:27], v[176:179]
ds_read_b64_tr_b16 v[96:97], v13 offset:53248
s_add_u32 m0, s65, 20480
v_mfma_f32_16x16x32_bf16 v[180:183], v[52:55], v[28:31], v[180:183]
buffer_load_dwordx4 v1, s[20:23], s85 offen offset:3072 sc1 lds
v_mfma_f32_16x16x32_bf16 v[184:187], v[52:55], v[32:35], v[184:187]
ds_read_b64_tr_b16 v[98:99], v13 offset:54016
v_mfma_f32_16x16x32_bf16 v[188:191], v[52:55], v[36:39], v[188:191]
ds_read_b64_tr_b16 v[100:101], v13 offset:59392
v_mfma_f32_16x16x32_bf16 v[116:119], v[52:55], v[20:23], v[116:119]
ds_read_b64_tr_b16 v[102:103], v13 offset:60160
v_mfma_f32_16x16x32_bf16 v[192:195], v[56:59], v[24:27], v[192:195]
s_add_u32 m0, s65, 24576
v_mfma_f32_16x16x32_bf16 v[196:199], v[56:59], v[28:31], v[196:199]
buffer_load_dwordx4 v243, s[20:23], s85 offen offset:0 sc1 lds
v_mfma_f32_16x16x32_bf16 v[200:203], v[56:59], v[32:35], v[200:203]
v_mfma_f32_16x16x32_bf16 v[204:207], v[56:59], v[36:39], v[204:207]
v_mfma_f32_16x16x32_bf16 v[208:211], v[60:63], v[24:27], v[208:211]
v_mfma_f32_16x16x32_bf16 v[212:215], v[60:63], v[28:31], v[212:215]
v_mfma_f32_16x16x32_bf16 v[216:219], v[60:63], v[32:35], v[216:219]
v_mfma_f32_16x16x32_bf16 v[220:223], v[60:63], v[36:39], v[220:223]
s_waitcnt lgkmcnt(0)
v_mfma_f32_16x16x32_bf16 v[104:107], v[80:83], v[20:23], v[104:107]
v_mfma_f32_16x16x32_bf16 v[108:111], v[84:87], v[20:23], v[108:111]
v_mfma_f32_16x16x32_bf16 v[112:115], v[88:91], v[20:23], v[112:115]
v_mfma_f32_16x16x32_bf16 v[116:119], v[92:95], v[20:23], v[116:119]
v_mfma_f32_16x16x32_bf16 v[128:131], v[80:83], v[64:67], v[128:131]
v_mfma_f32_16x16x32_bf16 v[132:135], v[80:83], v[68:71], v[132:135]
v_mfma_f32_16x16x32_bf16 v[136:139], v[80:83], v[72:75], v[136:139]
v_mfma_f32_16x16x32_bf16 v[140:143], v[80:83], v[76:79], v[140:143]
s_lshl_b32 s33, s24, 11
s_add_u32 s33, s33, 40960
v_add_u32 v16, s33, v1
ds_write_b128 v16, v[104:107]
ds_write_b128 v16, v[108:111] offset:1024
v_xor_b32 v16, 2048, v16
v_mfma_f32_16x16x32_bf16 v[144:147], v[84:87], v[64:67], v[144:147]
v_mfma_f32_16x16x32_bf16 v[148:151], v[84:87], v[68:71], v[148:151]
v_mfma_f32_16x16x32_bf16 v[152:155], v[84:87], v[72:75], v[152:155]
v_mfma_f32_16x16x32_bf16 v[156:159], v[84:87], v[76:79], v[156:159]
v_mfma_f32_16x16x32_bf16 v[160:163], v[88:91], v[64:67], v[160:163]
v_mfma_f32_16x16x32_bf16 v[164:167], v[88:91], v[68:71], v[164:167]
v_mfma_f32_16x16x32_bf16 v[168:171], v[88:91], v[72:75], v[168:171]
v_mfma_f32_16x16x32_bf16 v[172:175], v[88:91], v[76:79], v[172:175]
s_waitcnt lgkmcnt(0)
s_barrier
ds_read_b128 v[120:123], v16
ds_read_b128 v[124:127], v16 offset:1024
v_mfma_f32_16x16x32_bf16 v[176:179], v[92:95], v[64:67], v[176:179]
v_mfma_f32_16x16x32_bf16 v[180:183], v[92:95], v[68:71], v[180:183]
v_mfma_f32_16x16x32_bf16 v[184:187], v[92:95], v[72:75], v[184:187]
v_mfma_f32_16x16x32_bf16 v[188:191], v[92:95], v[76:79], v[188:191]
v_mfma_f32_16x16x32_bf16 v[192:195], v[96:99], v[64:67], v[192:195]
v_mfma_f32_16x16x32_bf16 v[196:199], v[96:99], v[68:71], v[196:199]
v_mfma_f32_16x16x32_bf16 v[200:203], v[96:99], v[72:75], v[200:203]
v_mfma_f32_16x16x32_bf16 v[204:207], v[96:99], v[76:79], v[204:207]
v_mfma_f32_16x16x32_bf16 v[208:211], v[100:103], v[64:67], v[208:211]
v_mfma_f32_16x16x32_bf16 v[212:215], v[100:103], v[68:71], v[212:215]
v_mfma_f32_16x16x32_bf16 v[216:219], v[100:103], v[72:75], v[216:219]
v_mfma_f32_16x16x32_bf16 v[220:223], v[100:103], v[76:79], v[220:223]
s_setprio 0
v_lshrrev_b32 v14, 4, v0
v_and_b32 v15, 1, v14
v_lshrrev_b32 v14, 1, v14
v_mul_u32_u24 v15, 49152, v15
v_lshl_add_u32 v15, v14, 8, v15
v_and_b32 v14, 15, v0
v_lshl_add_u32 v2, v14, 4, v15
v_add_u32 v3, 98304, v2
s_lshl_b32 s33, s27, 3
s_lshl_b32 s34, s30, 2
s_add_u32 s33, s33, s34
s_mul_i32 s33, s33, 49152
s_mul_i32 s34, s28, 3072
s_add_u32 s33, s33, s34
s_lshl_b32 s40, s40, 9
s_add_u32 s40, s40, s33
s_lshl_b32 s41, s41, 9
s_add_u32 s41, s41, s33
s_lshl_b32 s43, s43, 9
s_add_u32 s43, s43, s33
s_waitcnt vmcnt(10) lgkmcnt(0)
s_barrier
v_mov_b32 v24, v225
v_mov_b32 v26, v229
v_mov_b32 v28, v233
v_mov_b32 v30, v237
v_and_b32 v10, 15, v0
v_lshrrev_b32 v11, 4, v0
v_add_u32 v6, s65, v1
v_add_u32 v244, 4096, v6
s_add_u32 m0, s65, 40960
s_nop 0
buffer_load_dwordx4 v1, s[20:23], s87 offen offset:0 sc1 lds
v_pk_fma_f32 v[128:129], v[104:105], v[224:225], v[128:129] op_sel_hi:[1,0,1]
v_pk_fma_f32 v[130:131], v[106:107], v[224:225], v[130:131] op_sel_hi:[1,0,1]
v_pk_fma_f32 v[132:133], v[104:105], v[228:229], v[132:133] op_sel_hi:[1,0,1]
v_pk_fma_f32 v[134:135], v[106:107], v[228:229], v[134:135] op_sel_hi:[1,0,1]
v_pk_mul_f32 v[32:33], v[128:129], v[24:25] op_sel_hi:[1,0]
v_pk_mul_f32 v[34:35], v[130:131], v[24:25] op_sel_hi:[1,0]
v_pk_mul_f32 v[36:37], v[132:133], v[26:27] op_sel_hi:[1,0]
v_pk_mul_f32 v[38:39], v[134:135], v[26:27] op_sel_hi:[1,0]
s_add_u32 m0, s65, 40960
s_nop 0
buffer_load_dwordx4 v1, s[20:23], s87 offen offset:1024 sc1 lds
v_exp_f32 v32, v32
v_exp_f32 v33, v33
v_exp_f32 v34, v34
v_exp_f32 v35, v35
v_exp_f32 v36, v36
v_exp_f32 v37, v37
v_exp_f32 v38, v38
v_exp_f32 v39, v39
s_add_u32 m0, s65, 40960
s_nop 0
buffer_load_dwordx4 v1, s[20:23], s87 offen offset:2048 sc1 lds
v_pk_fma_f32 v[144:145], v[108:109], v[224:225], v[144:145] op_sel_hi:[1,0,1]
v_pk_fma_f32 v[146:147], v[110:111], v[224:225], v[146:147] op_sel_hi:[1,0,1]
v_pk_fma_f32 v[148:149], v[108:109], v[228:229], v[148:149] op_sel_hi:[1,0,1]
v_pk_fma_f32 v[150:151], v[110:111], v[228:229], v[150:151] op_sel_hi:[1,0,1]
v_pk_fma_f32 v[32:33], v[32:33], v[226:227], v[226:227]
v_pk_fma_f32 v[34:35], v[34:35], v[226:227], v[226:227]
v_pk_fma_f32 v[36:37], v[36:37], v[230:231], v[230:231]
v_pk_fma_f32 v[38:39], v[38:39], v[230:231], v[230:231]
s_add_u32 m0, s65, 40960
s_nop 0
buffer_load_dwordx4 v1, s[20:23], s87 offen offset:3072 sc1 lds
v_rcp_f32 v32, v32
v_rcp_f32 v33, v33
v_rcp_f32 v34, v34
v_rcp_f32 v35, v35
v_rcp_f32 v36, v36
v_rcp_f32 v37, v37
v_rcp_f32 v38, v38
v_rcp_f32 v39, v39
s_add_u32 m0, s65, 45056
s_nop 0
buffer_load_dwordx4 v243, s[20:23], s87 offen offset:0 sc1 lds
v_pk_mul_f32 v[128:129], v[128:129], v[144:145]
v_pk_mul_f32 v[130:131], v[130:131], v[146:147]
v_pk_mul_f32 v[132:133], v[132:133], v[148:149]
v_pk_mul_f32 v[134:135], v[134:135], v[150:151]
v_pk_mul_f32 v[128:129], v[128:129], v[32:33]
v_pk_mul_f32 v[130:131], v[130:131], v[34:35]
v_pk_mul_f32 v[132:133], v[132:133], v[36:37]
v_pk_mul_f32 v[134:135], v[134:135], v[38:39]
v_cvt_pk_bf16_f32 v64, v128, v129
v_cvt_pk_bf16_f32 v65, v130, v131
v_cvt_pk_bf16_f32 v66, v132, v133
v_cvt_pk_bf16_f32 v67, v134, v135
s_nop 0
v_permlane16_swap_b32 v64, v66
v_permlane16_swap_b32 v65, v67
buffer_store_dwordx4 v[64:67], v2, s[20:23], s40 offen sc1
s_add_u32 m0, s65, 61440
s_nop 0
buffer_load_dwordx4 v1, s[20:23], s89 offen offset:0 sc1 lds
v_pk_fma_f32 v[136:137], v[104:105], v[232:233], v[136:137] op_sel_hi:[1,0,1]
v_pk_fma_f32 v[138:139], v[106:107], v[232:233], v[138:139] op_sel_hi:[1,0,1]
v_pk_fma_f32 v[140:141], v[104:105], v[236:237], v[140:141] op_sel_hi:[1,0,1]
v_pk_fma_f32 v[142:143], v[106:107], v[236:237], v[142:143] op_sel_hi:[1,0,1]
v_pk_mul_f32 v[32:33], v[136:137], v[28:29] op_sel_hi:[1,0]
v_pk_mul_f32 v[34:35], v[138:139], v[28:29] op_sel_hi:[1,0]
v_pk_mul_f32 v[36:37], v[140:141], v[30:31] op_sel_hi:[1,0]
v_pk_mul_f32 v[38:39], v[142:143], v[30:31] op_sel_hi:[1,0]
s_add_u32 m0, s65, 61440
s_nop 0
buffer_load_dwordx4 v1, s[20:23], s89 offen offset:1024 sc1 lds
v_exp_f32 v32, v32
v_exp_f32 v33, v33
v_exp_f32 v34, v34
v_exp_f32 v35, v35
v_exp_f32 v36, v36
v_exp_f32 v37, v37
v_exp_f32 v38, v38
v_exp_f32 v39, v39
s_add_u32 m0, s65, 61440
s_nop 0
buffer_load_dwordx4 v1, s[20:23], s89 offen offset:2048 sc1 lds
v_pk_fma_f32 v[152:153], v[108:109], v[232:233], v[152:153] op_sel_hi:[1,0,1]
v_pk_fma_f32 v[154:155], v[110:111], v[232:233], v[154:155] op_sel_hi:[1,0,1]
v_pk_fma_f32 v[156:157], v[108:109], v[236:237], v[156:157] op_sel_hi:[1,0,1]
v_pk_fma_f32 v[158:159], v[110:111], v[236:237], v[158:159] op_sel_hi:[1,0,1]
v_pk_fma_f32 v[32:33], v[32:33], v[234:235], v[234:235]
v_pk_fma_f32 v[34:35], v[34:35], v[234:235], v[234:235]
v_pk_fma_f32 v[36:37], v[36:37], v[238:239], v[238:239]
v_pk_fma_f32 v[38:39], v[38:39], v[238:239], v[238:239]
s_add_u32 m0, s65, 61440
s_nop 0
buffer_load_dwordx4 v1, s[20:23], s89 offen offset:3072 sc1 lds
v_rcp_f32 v32, v32
v_rcp_f32 v33, v33
v_rcp_f32 v34, v34
v_rcp_f32 v35, v35
v_rcp_f32 v36, v36
v_rcp_f32 v37, v37
v_rcp_f32 v38, v38
v_rcp_f32 v39, v39
s_add_u32 m0, s65, 65536
s_nop 0
buffer_load_dwordx4 v243, s[20:23], s89 offen offset:0 sc1 lds
v_pk_mul_f32 v[136:137], v[136:137], v[152:153]
v_pk_mul_f32 v[138:139], v[138:139], v[154:155]
v_pk_mul_f32 v[140:141], v[140:141], v[156:157]
v_pk_mul_f32 v[142:143], v[142:143], v[158:159]
v_pk_mul_f32 v[136:137], v[136:137], v[32:33]
v_pk_mul_f32 v[138:139], v[138:139], v[34:35]
v_pk_mul_f32 v[140:141], v[140:141], v[36:37]
v_pk_mul_f32 v[142:143], v[142:143], v[38:39]
v_cvt_pk_bf16_f32 v68, v136, v137
v_cvt_pk_bf16_f32 v69, v138, v139
v_cvt_pk_bf16_f32 v70, v140, v141
v_cvt_pk_bf16_f32 v71, v142, v143
s_nop 0
v_permlane16_swap_b32 v68, v70
v_permlane16_swap_b32 v69, v71
buffer_store_dwordx4 v[68:71], v3, s[20:23], s40 offen sc1
v_pk_fma_f32 v[160:161], v[112:113], v[224:225], v[160:161] op_sel_hi:[1,0,1]
v_pk_fma_f32 v[162:163], v[114:115], v[224:225], v[162:163] op_sel_hi:[1,0,1]
v_pk_fma_f32 v[164:165], v[112:113], v[228:229], v[164:165] op_sel_hi:[1,0,1]
v_pk_fma_f32 v[166:167], v[114:115], v[228:229], v[166:167] op_sel_hi:[1,0,1]
v_pk_mul_f32 v[32:33], v[160:161], v[24:25] op_sel_hi:[1,0]
v_pk_mul_f32 v[34:35], v[162:163], v[24:25] op_sel_hi:[1,0]
v_pk_mul_f32 v[36:37], v[164:165], v[26:27] op_sel_hi:[1,0]
v_pk_mul_f32 v[38:39], v[166:167], v[26:27] op_sel_hi:[1,0]
buffer_load_dwordx4 v[40:43], v1, s[20:23], s78 offen offset:0 sc1
v_exp_f32 v32, v32
v_exp_f32 v33, v33
v_exp_f32 v34, v34
v_exp_f32 v35, v35
v_exp_f32 v36, v36
v_exp_f32 v37, v37
v_exp_f32 v38, v38
v_exp_f32 v39, v39
buffer_load_dwordx4 v[44:47], v1, s[20:23], s78 offen offset:1024 sc1
v_pk_fma_f32 v[176:177], v[116:117], v[224:225], v[176:177] op_sel_hi:[1,0,1]
v_pk_fma_f32 v[178:179], v[118:119], v[224:225], v[178:179] op_sel_hi:[1,0,1]
v_pk_fma_f32 v[180:181], v[116:117], v[228:229], v[180:181] op_sel_hi:[1,0,1]
v_pk_fma_f32 v[182:183], v[118:119], v[228:229], v[182:183] op_sel_hi:[1,0,1]
v_pk_fma_f32 v[32:33], v[32:33], v[226:227], v[226:227]
v_pk_fma_f32 v[34:35], v[34:35], v[226:227], v[226:227]
v_pk_fma_f32 v[36:37], v[36:37], v[230:231], v[230:231]
v_pk_fma_f32 v[38:39], v[38:39], v[230:231], v[230:231]
buffer_load_dwordx4 v[48:51], v1, s[20:23], s78 offen offset:2048 sc1
v_rcp_f32 v32, v32
v_rcp_f32 v33, v33
v_rcp_f32 v34, v34
v_rcp_f32 v35, v35
v_rcp_f32 v36, v36
v_rcp_f32 v37, v37
v_rcp_f32 v38, v38
v_rcp_f32 v39, v39
buffer_load_dwordx4 v[52:55], v1, s[20:23], s78 offen offset:3072 sc1
v_pk_mul_f32 v[160:161], v[160:161], v[176:177]
v_pk_mul_f32 v[162:163], v[162:163], v[178:179]
v_pk_mul_f32 v[164:165], v[164:165], v[180:181]
v_pk_mul_f32 v[166:167], v[166:167], v[182:183]
v_pk_mul_f32 v[160:161], v[160:161], v[32:33]
v_pk_mul_f32 v[162:163], v[162:163], v[34:35]
v_pk_mul_f32 v[164:165], v[164:165], v[36:37]
v_pk_mul_f32 v[166:167], v[166:167], v[38:39]
v_cvt_pk_bf16_f32 v64, v160, v161
v_cvt_pk_bf16_f32 v65, v162, v163
v_cvt_pk_bf16_f32 v66, v164, v165
v_cvt_pk_bf16_f32 v67, v166, v167
s_nop 0
v_permlane16_swap_b32 v64, v66
v_permlane16_swap_b32 v65, v67
buffer_store_dwordx4 v[64:67], v2, s[20:23], s41 offen sc1
buffer_load_dwordx4 v[56:59], v243, s[20:23], s78 offen offset:0 sc1
v_pk_fma_f32 v[168:169], v[112:113], v[232:233], v[168:169] op_sel_hi:[1,0,1]
v_pk_fma_f32 v[170:171], v[114:115], v[232:233], v[170:171] op_sel_hi:[1,0,1]
v_pk_fma_f32 v[172:173], v[112:113], v[236:237], v[172:173] op_sel_hi:[1,0,1]
v_pk_fma_f32 v[174:175], v[114:115], v[236:237], v[174:175] op_sel_hi:[1,0,1]
v_pk_mul_f32 v[32:33], v[168:169], v[28:29] op_sel_hi:[1,0]
v_pk_mul_f32 v[34:35], v[170:171], v[28:29] op_sel_hi:[1,0]
v_pk_mul_f32 v[36:37], v[172:173], v[30:31] op_sel_hi:[1,0]
v_pk_mul_f32 v[38:39], v[174:175], v[30:31] op_sel_hi:[1,0]
buffer_load_dwordx4 v[72:75], v1, s[20:23], s79 offen offset:0 sc1
v_exp_f32 v32, v32
v_exp_f32 v33, v33
v_exp_f32 v34, v34
v_exp_f32 v35, v35
v_exp_f32 v36, v36
v_exp_f32 v37, v37
v_exp_f32 v38, v38
v_exp_f32 v39, v39
buffer_load_dwordx4 v[76:79], v1, s[20:23], s79 offen offset:1024 sc1
v_pk_fma_f32 v[184:185], v[116:117], v[232:233], v[184:185] op_sel_hi:[1,0,1]
v_pk_fma_f32 v[186:187], v[118:119], v[232:233], v[186:187] op_sel_hi:[1,0,1]
v_pk_fma_f32 v[188:189], v[116:117], v[236:237], v[188:189] op_sel_hi:[1,0,1]
v_pk_fma_f32 v[190:191], v[118:119], v[236:237], v[190:191] op_sel_hi:[1,0,1]
v_pk_fma_f32 v[32:33], v[32:33], v[234:235], v[234:235]
v_pk_fma_f32 v[34:35], v[34:35], v[234:235], v[234:235]
v_pk_fma_f32 v[36:37], v[36:37], v[238:239], v[238:239]
v_pk_fma_f32 v[38:39], v[38:39], v[238:239], v[238:239]
buffer_load_dwordx4 v[80:83], v1, s[20:23], s79 offen offset:2048 sc1
v_rcp_f32 v32, v32
v_rcp_f32 v33, v33
v_rcp_f32 v34, v34
v_rcp_f32 v35, v35
v_rcp_f32 v36, v36
v_rcp_f32 v37, v37
v_rcp_f32 v38, v38
v_rcp_f32 v39, v39
buffer_load_dwordx4 v[84:87], v1, s[20:23], s79 offen offset:3072 sc1
v_pk_mul_f32 v[168:169], v[168:169], v[184:185]
v_pk_mul_f32 v[170:171], v[170:171], v[186:187]
v_pk_mul_f32 v[172:173], v[172:173], v[188:189]
v_pk_mul_f32 v[174:175], v[174:175], v[190:191]
v_pk_mul_f32 v[168:169], v[168:169], v[32:33]
v_pk_mul_f32 v[170:171], v[170:171], v[34:35]
v_pk_mul_f32 v[172:173], v[172:173], v[36:37]
v_pk_mul_f32 v[174:175], v[174:175], v[38:39]
v_cvt_pk_bf16_f32 v68, v168, v169
v_cvt_pk_bf16_f32 v69, v170, v171
v_cvt_pk_bf16_f32 v70, v172, v173
v_cvt_pk_bf16_f32 v71, v174, v175
s_nop 0
v_permlane16_swap_b32 v68, v70
v_permlane16_swap_b32 v69, v71
buffer_store_dwordx4 v[68:71], v3, s[20:23], s41 offen sc1
buffer_load_dwordx4 v[88:91], v243, s[20:23], s79 offen offset:0 sc1
v_fmac_f32 v192, v120, v224
v_fmac_f32 v193, v121, v224
v_fmac_f32 v194, v122, v224
v_fmac_f32 v195, v123, v224
v_fmac_f32 v196, v120, v228
v_fmac_f32 v197, v121, v228
v_fmac_f32 v198, v122, v228
v_fmac_f32 v199, v123, v228
v_mul_f32 v32, v192, v24
v_mul_f32 v33, v193, v24
v_mul_f32 v34, v194, v24
v_mul_f32 v35, v195, v24
v_mul_f32 v36, v196, v26
v_mul_f32 v37, v197, v26
v_mul_f32 v38, v198, v26
v_mul_f32 v39, v199, v26
v_exp_f32 v32, v32
v_exp_f32 v33, v33
v_exp_f32 v34, v34
v_exp_f32 v35, v35
v_exp_f32 v36, v36
v_exp_f32 v37, v37
v_exp_f32 v38, v38
v_exp_f32 v39, v39
v_fmac_f32 v208, v124, v224
v_fmac_f32 v209, v125, v224
v_fmac_f32 v210, v126, v224
v_fmac_f32 v211, v127, v224
v_fmac_f32 v212, v124, v228
v_fmac_f32 v213, v125, v228
v_fmac_f32 v214, v126, v228
v_fmac_f32 v215, v127, v228
v_fma_f32 v32, v32, v226, v226
v_fma_f32 v33, v33, v227, v227
v_fma_f32 v34, v34, v226, v226
v_fma_f32 v35, v35, v227, v227
v_fma_f32 v36, v36, v230, v230
v_fma_f32 v37, v37, v231, v231
v_fma_f32 v38, v38, v230, v230
v_fma_f32 v39, v39, v231, v231
v_rcp_f32 v32, v32
v_rcp_f32 v33, v33
v_rcp_f32 v34, v34
v_rcp_f32 v35, v35
v_rcp_f32 v36, v36
v_rcp_f32 v37, v37
v_rcp_f32 v38, v38
v_rcp_f32 v39, v39
v_mul_f32 v192, v192, v208
v_mul_f32 v193, v193, v209
v_mul_f32 v194, v194, v210
v_mul_f32 v195, v195, v211
v_mul_f32 v196, v196, v212
v_mul_f32 v197, v197, v213
v_mul_f32 v198, v198, v214
v_mul_f32 v199, v199, v215
v_mul_f32 v192, v192, v32
v_mul_f32 v193, v193, v33
v_mul_f32 v194, v194, v34
v_mul_f32 v195, v195, v35
v_mul_f32 v196, v196, v36
v_mul_f32 v197, v197, v37
v_mul_f32 v198, v198, v38
v_mul_f32 v199, v199, v39
v_cvt_pk_bf16_f32 v64, v192, v193
v_cvt_pk_bf16_f32 v65, v194, v195
v_cvt_pk_bf16_f32 v66, v196, v197
v_cvt_pk_bf16_f32 v67, v198, v199
s_nop 0
v_permlane16_swap_b32 v64, v66
v_permlane16_swap_b32 v65, v67
buffer_store_dwordx4 v[64:67], v2, s[20:23], s43 offen sc1
v_fmac_f32 v200, v120, v232
v_fmac_f32 v201, v121, v232
v_fmac_f32 v202, v122, v232
v_fmac_f32 v203, v123, v232
v_fmac_f32 v204, v120, v236
v_fmac_f32 v205, v121, v236
v_fmac_f32 v206, v122, v236
v_fmac_f32 v207, v123, v236
v_mul_f32 v32, v200, v28
v_mul_f32 v33, v201, v28
v_mul_f32 v34, v202, v28
v_mul_f32 v35, v203, v28
v_mul_f32 v36, v204, v30
v_mul_f32 v37, v205, v30
v_mul_f32 v38, v206, v30
v_mul_f32 v39, v207, v30
v_exp_f32 v32, v32
v_exp_f32 v33, v33
v_exp_f32 v34, v34
v_exp_f32 v35, v35
v_exp_f32 v36, v36
v_exp_f32 v37, v37
v_exp_f32 v38, v38
v_exp_f32 v39, v39
v_fmac_f32 v216, v124, v232
v_fmac_f32 v217, v125, v232
v_fmac_f32 v218, v126, v232
v_fmac_f32 v219, v127, v232
v_fmac_f32 v220, v124, v236
v_fmac_f32 v221, v125, v236
v_fmac_f32 v222, v126, v236
v_fmac_f32 v223, v127, v236
v_fma_f32 v32, v32, v234, v234
v_fma_f32 v33, v33, v235, v235
v_fma_f32 v34, v34, v234, v234
v_fma_f32 v35, v35, v235, v235
v_fma_f32 v36, v36, v238, v238
v_fma_f32 v37, v37, v239, v239
v_fma_f32 v38, v38, v238, v238
v_fma_f32 v39, v39, v239, v239
v_rcp_f32 v32, v32
v_rcp_f32 v33, v33
v_rcp_f32 v34, v34
v_rcp_f32 v35, v35
v_rcp_f32 v36, v36
v_rcp_f32 v37, v37
v_rcp_f32 v38, v38
v_rcp_f32 v39, v39
v_mul_f32 v200, v200, v216
v_mul_f32 v201, v201, v217
v_mul_f32 v202, v202, v218
v_mul_f32 v203, v203, v219
v_mul_f32 v204, v204, v220
v_mul_f32 v205, v205, v221
v_mul_f32 v206, v206, v222
v_mul_f32 v207, v207, v223
v_mul_f32 v200, v200, v32
v_mul_f32 v201, v201, v33
v_mul_f32 v202, v202, v34
v_mul_f32 v203, v203, v35
v_mul_f32 v204, v204, v36
v_mul_f32 v205, v205, v37
v_mul_f32 v206, v206, v38
v_mul_f32 v207, v207, v39
v_cvt_pk_bf16_f32 v68, v200, v201
v_cvt_pk_bf16_f32 v69, v202, v203
v_cvt_pk_bf16_f32 v70, v204, v205
v_cvt_pk_bf16_f32 v71, v206, v207
s_nop 0
v_permlane16_swap_b32 v68, v70
v_permlane16_swap_b32 v69, v71
buffer_store_dwordx4 v[68:71], v3, s[20:23], s43 offen sc1
s_lshl_b32 s33, s27, 3
s_lshl_b32 s34, s30, 2
s_add_u32 s33, s33, s34
s_lshr_b32 s34, s28, 2
s_add_u32 s33, s33, s34
s_lshl_b32 s33, s33, 10
s_and_b32 s34, s28, 3
s_lshl_b32 s34, s34, 1
s_add_u32 s34, s34, s31
s_lshl_b32 s34, s34, 7
s_add_u32 s33, s33, s34
s_add_u32 s33, s33, 14745600
v_mov_b32 v8, s33
v_mov_b32 v9, 1
v_mov_b32 v104, 0
v_mov_b32 v105, 0
v_mov_b32 v106, 0
v_mov_b32 v107, 0
v_mov_b32 v108, 0
v_mov_b32 v109, 0
v_mov_b32 v110, 0
v_mov_b32 v111, 0
v_mov_b32 v112, 0
v_mov_b32 v113, 0
v_mov_b32 v114, 0
v_mov_b32 v115, 0
v_mov_b32 v116, 0
v_mov_b32 v117, 0
v_mov_b32 v118, 0
v_mov_b32 v119, 0
v_mov_b32 v120, 0
v_mov_b32 v121, 0
v_mov_b32 v122, 0
v_mov_b32 v123, 0
v_mov_b32 v124, 0
v_mov_b32 v125, 0
v_mov_b32 v126, 0
v_mov_b32 v127, 0
v_mov_b32 v188, 0
v_mov_b32 v189, 0
v_mov_b32 v190, 0
v_mov_b32 v191, 0
v_mov_b32 v192, 0
v_mov_b32 v193, 0
v_mov_b32 v194, 0
v_mov_b32 v195, 0
v_mov_b32 v196, 0
v_mov_b32 v197, 0
v_mov_b32 v198, 0
v_mov_b32 v199, 0
v_mov_b32 v200, 0
v_mov_b32 v201, 0
v_mov_b32 v202, 0
v_mov_b32 v203, 0
v_mov_b32 v204, 0
v_mov_b32 v205, 0
v_mov_b32 v206, 0
v_mov_b32 v207, 0
v_mov_b32 v208, 0
v_mov_b32 v209, 0
v_mov_b32 v210, 0
v_mov_b32 v211, 0
v_mov_b32 v212, 0
v_mov_b32 v213, 0
v_mov_b32 v214, 0
v_mov_b32 v215, 0
v_mov_b32 v216, 0
v_mov_b32 v217, 0
v_mov_b32 v218, 0
v_mov_b32 v219, 0
v_mov_b32 v220, 0
v_mov_b32 v221, 0
v_mov_b32 v222, 0
v_mov_b32 v223, 0
v_mov_b32 v224, 0
v_mov_b32 v225, 0
v_mov_b32 v226, 0
v_mov_b32 v227, 0
v_mov_b32 v228, 0
v_mov_b32 v229, 0
v_mov_b32 v230, 0
v_mov_b32 v231, 0
v_mov_b32 v232, 0
v_mov_b32 v233, 0
v_mov_b32 v234, 0
v_mov_b32 v235, 0
v_mov_b32 v236, 0
v_mov_b32 v237, 0
v_mov_b32 v238, 0
v_mov_b32 v239, 0
v_mov_b32 v248, 0
v_mov_b32 v249, 0
v_mov_b32 v250, 0
v_mov_b32 v251, 0
s_xor_b32 s33, s24, 0
s_mul_i32 s33, s33, 49152
v_add_u32 v2, s33, v1
s_xor_b32 s33, s24, 1
s_mul_i32 s33, s33, 49152
v_add_u32 v3, s33, v1
s_xor_b32 s33, s24, 2
s_mul_i32 s33, s33, 49152
v_add_u32 v4, s33, v1
s_xor_b32 s33, s24, 3
s_mul_i32 s33, s33, 49152
v_add_u32 v5, s33, v1
v_add_u32 v7, s65, v1
v_lshlrev_b32 v12, 4, v10
v_lshl_add_u32 v12, v11, 14, v12
s_mul_i32 s40, s61, 327680
s_lshl_b32 s33, s60, 9
s_add_u32 s40, s40, s33
s_lshl_b32 s33, s31, 8
s_add_u32 s40, s40, s33
s_lshl_b32 s33, s30, 3
s_add_u32 s40, s40, s33
s_add_u32 s40, s40, 11534336
s_lshl_b32 s33, s60, 2
s_add_u32 s33, s33, s24
s_lshl_b32 s33, s33, 10
s_add_u32 s41, s33, 14745600
v_and_b32 v13, 7, v0
v_lshlrev_b32 v13, 7, v13
s_waitcnt vmcnt(0)
v_cmp_eq_u32 vcc, 0, v0
s_nop 0
s_and_saveexec_b64 s[34:35], vcc
buffer_store_dword v9, v8, s[20:23], 0 offen sc1
s_mov_b64 exec, s[34:35]
s_barrier
buffer_load_dwordx4 v[128:131], v1, s[20:23], s80 offen offset:0 sc1
buffer_load_dwordx4 v[132:135], v1, s[20:23], s80 offen offset:1024 sc1
buffer_load_dwordx4 v[136:139], v1, s[20:23], s80 offen offset:2048 sc1
buffer_load_dwordx4 v[140:143], v1, s[20:23], s80 offen offset:3072 sc1
buffer_load_dwordx4 v[144:147], v243, s[20:23], s80 offen offset:0 sc1
buffer_load_dwordx4 v[148:151], v1, s[20:23], s81 offen offset:0 sc1
buffer_load_dwordx4 v[152:155], v1, s[20:23], s81 offen offset:1024 sc1
buffer_load_dwordx4 v[156:159], v1, s[20:23], s81 offen offset:2048 sc1
buffer_load_dwordx4 v[160:163], v1, s[20:23], s81 offen offset:3072 sc1
buffer_load_dwordx4 v[164:167], v243, s[20:23], s81 offen offset:0 sc1
buffer_load_dwordx4 v[168:171], v1, s[20:23], s82 offen offset:0 sc1
buffer_load_dwordx4 v[172:175], v1, s[20:23], s82 offen offset:1024 sc1
buffer_load_dwordx4 v[176:179], v1, s[20:23], s82 offen offset:2048 sc1
buffer_load_dwordx4 v[180:183], v1, s[20:23], s82 offen offset:3072 sc1
buffer_load_dwordx4 v[184:187], v243, s[20:23], s82 offen offset:0 sc1
s_mov_b32 s42, 0
buffer_load_dword v9, v13, s[20:23], s41 offen sc1
s_waitcnt vmcnt(0)
L_h_p:
v_cmp_ne_u32 vcc, 1, v9
s_cbranch_vccz L_h_ok
s_add_u32 s42, s42, 1
s_cmp_gt_u32 s42, 20000
s_cbranch_scc1 L_h_ok
s_sleep 4
buffer_load_dword v9, v13, s[20:23], s41 offen sc1
s_waitcnt vmcnt(0)
s_branch L_h_p
L_h_ok:
buffer_load_dwordx4 v[16:19], v2, s[20:23], s66 offen sc1
buffer_load_dwordx4 v[20:23], v3, s[20:23], s66 offen sc1
buffer_load_dwordx4 v[24:27], v4, s[20:23], s66 offen sc1
buffer_load_dwordx4 v[28:31], v5, s[20:23], s66 offen sc1
buffer_load_dwordx4 v[32:35], v2, s[20:23], s67 offen sc1
buffer_load_dwordx4 v[36:39], v3, s[20:23], s67 offen sc1
buffer_load_dwordx4 v[60:63], v4, s[20:23], s67 offen sc1
buffer_load_dwordx4 v[64:67], v5, s[20:23], s67 offen sc1
buffer_load_dwordx4 v[68:71], v2, s[20:23], s68 offen sc1
buffer_load_dwordx4 v[92:95], v3, s[20:23], s68 offen sc1
buffer_load_dwordx4 v[96:99], v4, s[20:23], s68 offen sc1
buffer_load_dwordx4 v[100:103], v5, s[20:23], s68 offen sc1
v_cmp_gt_u32 vcc, 32, v0
v_mov_b32 v8, 0x40000000
s_nop 0
v_cndmask_b32 v245, v8, v242, vcc
s_lshl_b32 s43, s60, 6
s_lshl_b32 s33, s24, 4
s_add_u32 s43, s43, s33
s_mul_i32 s43, s43, 1280
s_mul_i32 s33, s61, 160
s_add_u32 s43, s43, s33
s_mul_i32 s41, s61, 2560
s_add_u32 s41, s41, 14876672
v_min_u32 v8, 19, v0
v_lshlrev_b32 v8, 7, v8
s_waitcnt vmcnt(8) lgkmcnt(0)
v_mfma_f32_16x16x32_bf16 v[104:107], v[40:43], v[16:19], v[104:107]
v_mfma_f32_16x16x32_bf16 v[108:111], v[44:47], v[16:19], v[108:111]
v_mfma_f32_16x16x32_bf16 v[112:115], v[48:51], v[16:19], v[112:115]
v_mfma_f32_16x16x32_bf16 v[116:119], v[52:55], v[16:19], v[116:119]
v_mfma_f32_16x16x32_bf16 v[120:123], v[56:59], v[16:19], v[120:123]
v_mfma_f32_16x16x32_bf16 v[124:127], v[40:43], v[20:23], v[124:127]
v_mfma_f32_16x16x32_bf16 v[188:191], v[44:47], v[20:23], v[188:191]
v_mfma_f32_16x16x32_bf16 v[192:195], v[48:51], v[20:23], v[192:195]
v_mfma_f32_16x16x32_bf16 v[196:199], v[52:55], v[20:23], v[196:199]
v_mfma_f32_16x16x32_bf16 v[200:203], v[56:59], v[20:23], v[200:203]
v_mfma_f32_16x16x32_bf16 v[204:207], v[40:43], v[24:27], v[204:207]
v_mfma_f32_16x16x32_bf16 v[208:211], v[44:47], v[24:27], v[208:211]
v_mfma_f32_16x16x32_bf16 v[212:215], v[48:51], v[24:27], v[212:215]
v_mfma_f32_16x16x32_bf16 v[216:219], v[52:55], v[24:27], v[216:219]
v_mfma_f32_16x16x32_bf16 v[220:223], v[56:59], v[24:27], v[220:223]
v_mfma_f32_16x16x32_bf16 v[224:227], v[40:43], v[28:31], v[224:227]
v_mfma_f32_16x16x32_bf16 v[228:231], v[44:47], v[28:31], v[228:231]
v_mfma_f32_16x16x32_bf16 v[232:235], v[48:51], v[28:31], v[232:235]
v_mfma_f32_16x16x32_bf16 v[236:239], v[52:55], v[28:31], v[236:239]
v_mfma_f32_16x16x32_bf16 v[248:251], v[56:59], v[28:31], v[248:251]
s_waitcnt vmcnt(4) lgkmcnt(0)
v_mfma_f32_16x16x32_bf16 v[104:107], v[72:75], v[32:35], v[104:107]
buffer_load_dwordx4 v[16:19], v2, s[20:23], s69 offen sc1
v_mfma_f32_16x16x32_bf16 v[108:111], v[76:79], v[32:35], v[108:111]
ds_read_b128 v[40:43], v6 offset:0
v_mfma_f32_16x16x32_bf16 v[112:115], v[80:83], v[32:35], v[112:115]
buffer_load_dwordx4 v[20:23], v3, s[20:23], s69 offen sc1
v_mfma_f32_16x16x32_bf16 v[116:119], v[84:87], v[32:35], v[116:119]
ds_read_b128 v[44:47], v6 offset:1024
v_mfma_f32_16x16x32_bf16 v[120:123], v[88:91], v[32:35], v[120:123]
buffer_load_dwordx4 v[24:27], v4, s[20:23], s69 offen sc1
v_mfma_f32_16x16x32_bf16 v[124:127], v[72:75], v[36:39], v[124:127]
ds_read_b128 v[48:51], v6 offset:2048
v_mfma_f32_16x16x32_bf16 v[188:191], v[76:79], v[36:39], v[188:191]
buffer_load_dwordx4 v[28:31], v5, s[20:23], s69 offen sc1
v_mfma_f32_16x16x32_bf16 v[192:195], v[80:83], v[36:39], v[192:195]
ds_read_b128 v[52:55], v6 offset:3072
v_mfma_f32_16x16x32_bf16 v[196:199], v[84:87], v[36:39], v[196:199]
ds_read_b128 v[56:59], v244 offset:0
v_mfma_f32_16x16x32_bf16 v[200:203], v[88:91], v[36:39], v[200:203]
v_mfma_f32_16x16x32_bf16 v[204:207], v[72:75], v[60:63], v[204:207]
v_mfma_f32_16x16x32_bf16 v[208:211], v[76:79], v[60:63], v[208:211]
v_mfma_f32_16x16x32_bf16 v[212:215], v[80:83], v[60:63], v[212:215]
v_mfma_f32_16x16x32_bf16 v[216:219], v[84:87], v[60:63], v[216:219]
v_mfma_f32_16x16x32_bf16 v[220:223], v[88:91], v[60:63], v[220:223]
v_mfma_f32_16x16x32_bf16 v[224:227], v[72:75], v[64:67], v[224:227]
v_mfma_f32_16x16x32_bf16 v[228:231], v[76:79], v[64:67], v[228:231]
v_mfma_f32_16x16x32_bf16 v[232:235], v[80:83], v[64:67], v[232:235]
v_mfma_f32_16x16x32_bf16 v[236:239], v[84:87], v[64:67], v[236:239]
v_mfma_f32_16x16x32_bf16 v[248:251], v[88:91], v[64:67], v[248:251]
s_waitcnt vmcnt(4) lgkmcnt(0)
v_mfma_f32_16x16x32_bf16 v[104:107], v[128:131], v[68:71], v[104:107]
buffer_load_dwordx4 v[32:35], v2, s[20:23], s70 offen sc1
v_mfma_f32_16x16x32_bf16 v[108:111], v[132:135], v[68:71], v[108:111]
buffer_load_dwordx4 v[36:39], v3, s[20:23], s70 offen sc1
v_mfma_f32_16x16x32_bf16 v[112:115], v[136:139], v[68:71], v[112:115]
buffer_load_dwordx4 v[60:63], v4, s[20:23], s70 offen sc1
v_mfma_f32_16x16x32_bf16 v[116:119], v[140:143], v[68:71], v[116:119]
buffer_load_dwordx4 v[64:67], v5, s[20:23], s70 offen sc1
v_mfma_f32_16x16x32_bf16 v[120:123], v[144:147], v[68:71], v[120:123]
buffer_load_dwordx4 v[72:75], v1, s[20:23], s84 offen offset:0 sc1
v_mfma_f32_16x16x32_bf16 v[124:127], v[128:131], v[92:95], v[124:127]
buffer_load_dwordx4 v[76:79], v1, s[20:23], s84 offen offset:1024 sc1
v_mfma_f32_16x16x32_bf16 v[188:191], v[132:135], v[92:95], v[188:191]
buffer_load_dwordx4 v[80:83], v1, s[20:23], s84 offen offset:2048 sc1
v_mfma_f32_16x16x32_bf16 v[192:195], v[136:139], v[92:95], v[192:195]
buffer_load_dwordx4 v[84:87], v1, s[20:23], s84 offen offset:3072 sc1
v_mfma_f32_16x16x32_bf16 v[196:199], v[140:143], v[92:95], v[196:199]
buffer_load_dwordx4 v[88:91], v243, s[20:23], s84 offen offset:0 sc1
v_mfma_f32_16x16x32_bf16 v[200:203], v[144:147], v[92:95], v[200:203]
v_mfma_f32_16x16x32_bf16 v[204:207], v[128:131], v[96:99], v[204:207]
v_mfma_f32_16x16x32_bf16 v[208:211], v[132:135], v[96:99], v[208:211]
v_mfma_f32_16x16x32_bf16 v[212:215], v[136:139], v[96:99], v[212:215]
v_mfma_f32_16x16x32_bf16 v[216:219], v[140:143], v[96:99], v[216:219]
v_mfma_f32_16x16x32_bf16 v[220:223], v[144:147], v[96:99], v[220:223]
v_mfma_f32_16x16x32_bf16 v[224:227], v[128:131], v[100:103], v[224:227]
v_mfma_f32_16x16x32_bf16 v[228:231], v[132:135], v[100:103], v[228:231]
v_mfma_f32_16x16x32_bf16 v[232:235], v[136:139], v[100:103], v[232:235]
v_mfma_f32_16x16x32_bf16 v[236:239], v[140:143], v[100:103], v[236:239]
v_mfma_f32_16x16x32_bf16 v[248:251], v[144:147], v[100:103], v[248:251]
s_waitcnt vmcnt(9) lgkmcnt(0)
v_mfma_f32_16x16x32_bf16 v[104:107], v[148:151], v[16:19], v[104:107]
buffer_load_dwordx4 v[68:71], v2, s[20:23], s71 offen sc1
v_mfma_f32_16x16x32_bf16 v[108:111], v[152:155], v[16:19], v[108:111]
ds_read_b128 v[128:131], v6 offset:20480
v_mfma_f32_16x16x32_bf16 v[112:115], v[156:159], v[16:19], v[112:115]
buffer_load_dwordx4 v[92:95], v3, s[20:23], s71 offen sc1
v_mfma_f32_16x16x32_bf16 v[116:119], v[160:163], v[16:19], v[116:119]
ds_read_b128 v[132:135], v6 offset:21504
v_mfma_f32_16x16x32_bf16 v[120:123], v[164:167], v[16:19], v[120:123]
buffer_load_dwordx4 v[96:99], v4, s[20:23], s71 offen sc1
v_mfma_f32_16x16x32_bf16 v[124:127], v[148:151], v[20:23], v[124:127]
ds_read_b128 v[136:139], v6 offset:22528
v_mfma_f32_16x16x32_bf16 v[188:191], v[152:155], v[20:23], v[188:191]
buffer_load_dwordx4 v[100:103], v5, s[20:23], s71 offen sc1
v_mfma_f32_16x16x32_bf16 v[192:195], v[156:159], v[20:23], v[192:195]
ds_read_b128 v[140:143], v6 offset:23552
v_mfma_f32_16x16x32_bf16 v[196:199], v[160:163], v[20:23], v[196:199]
ds_read_b128 v[144:147], v244 offset:20480
v_mfma_f32_16x16x32_bf16 v[200:203], v[164:167], v[20:23], v[200:203]
v_mfma_f32_16x16x32_bf16 v[204:207], v[148:151], v[24:27], v[204:207]
v_mfma_f32_16x16x32_bf16 v[208:211], v[152:155], v[24:27], v[208:211]
v_mfma_f32_16x16x32_bf16 v[212:215], v[156:159], v[24:27], v[212:215]
v_mfma_f32_16x16x32_bf16 v[216:219], v[160:163], v[24:27], v[216:219]
v_mfma_f32_16x16x32_bf16 v[220:223], v[164:167], v[24:27], v[220:223]
v_mfma_f32_16x16x32_bf16 v[224:227], v[148:151], v[28:31], v[224:227]
v_mfma_f32_16x16x32_bf16 v[228:231], v[152:155], v[28:31], v[228:231]
v_mfma_f32_16x16x32_bf16 v[232:235], v[156:159], v[28:31], v[232:235]
v_mfma_f32_16x16x32_bf16 v[236:239], v[160:163], v[28:31], v[236:239]
v_mfma_f32_16x16x32_bf16 v[248:251], v[164:167], v[28:31], v[248:251]
s_waitcnt vmcnt(9) lgkmcnt(0)
v_mfma_f32_16x16x32_bf16 v[104:107], v[168:171], v[32:35], v[104:107]
buffer_load_dwordx4 v[16:19], v2, s[20:23], s72 offen sc1
v_mfma_f32_16x16x32_bf16 v[108:111], v[172:175], v[32:35], v[108:111]
buffer_load_dwordx4 v[20:23], v3, s[20:23], s72 offen sc1
v_mfma_f32_16x16x32_bf16 v[112:115], v[176:179], v[32:35], v[112:115]
buffer_load_dwordx4 v[24:27], v4, s[20:23], s72 offen sc1
v_mfma_f32_16x16x32_bf16 v[116:119], v[180:183], v[32:35], v[116:119]
buffer_load_dwordx4 v[28:31], v5, s[20:23], s72 offen sc1
v_mfma_f32_16x16x32_bf16 v[120:123], v[184:187], v[32:35], v[120:123]
buffer_load_dwordx4 v[148:151], v1, s[20:23], s86 offen offset:0 sc1
v_mfma_f32_16x16x32_bf16 v[124:127], v[168:171], v[36:39], v[124:127]
buffer_load_dwordx4 v[152:155], v1, s[20:23], s86 offen offset:1024 sc1
v_mfma_f32_16x16x32_bf16 v[188:191], v[172:175], v[36:39], v[188:191]
buffer_load_dwordx4 v[156:159], v1, s[20:23], s86 offen offset:2048 sc1
v_mfma_f32_16x16x32_bf16 v[192:195], v[176:179], v[36:39], v[192:195]
buffer_load_dwordx4 v[160:163], v1, s[20:23], s86 offen offset:3072 sc1
v_mfma_f32_16x16x32_bf16 v[196:199], v[180:183], v[36:39], v[196:199]
buffer_load_dwordx4 v[164:167], v243, s[20:23], s86 offen offset:0 sc1
v_mfma_f32_16x16x32_bf16 v[200:203], v[184:187], v[36:39], v[200:203]
v_mfma_f32_16x16x32_bf16 v[204:207], v[168:171], v[60:63], v[204:207]
v_mfma_f32_16x16x32_bf16 v[208:211], v[172:175], v[60:63], v[208:211]
v_mfma_f32_16x16x32_bf16 v[212:215], v[176:179], v[60:63], v[212:215]
v_mfma_f32_16x16x32_bf16 v[216:219], v[180:183], v[60:63], v[216:219]
v_mfma_f32_16x16x32_bf16 v[220:223], v[184:187], v[60:63], v[220:223]
v_mfma_f32_16x16x32_bf16 v[224:227], v[168:171], v[64:67], v[224:227]
v_mfma_f32_16x16x32_bf16 v[228:231], v[172:175], v[64:67], v[228:231]
v_mfma_f32_16x16x32_bf16 v[232:235], v[176:179], v[64:67], v[232:235]
v_mfma_f32_16x16x32_bf16 v[236:239], v[180:183], v[64:67], v[236:239]
v_mfma_f32_16x16x32_bf16 v[248:251], v[184:187], v[64:67], v[248:251]
s_waitcnt vmcnt(9) lgkmcnt(0)
v_mfma_f32_16x16x32_bf16 v[104:107], v[40:43], v[68:71], v[104:107]
buffer_load_dwordx4 v[32:35], v2, s[20:23], s73 offen sc1
v_mfma_f32_16x16x32_bf16 v[108:111], v[44:47], v[68:71], v[108:111]
ds_read_b128 v[168:171], v6 offset:40960
v_mfma_f32_16x16x32_bf16 v[112:115], v[48:51], v[68:71], v[112:115]
buffer_load_dwordx4 v[36:39], v3, s[20:23], s73 offen sc1
v_mfma_f32_16x16x32_bf16 v[116:119], v[52:55], v[68:71], v[116:119]
ds_read_b128 v[172:175], v6 offset:41984
v_mfma_f32_16x16x32_bf16 v[120:123], v[56:59], v[68:71], v[120:123]
buffer_load_dwordx4 v[60:63], v4, s[20:23], s73 offen sc1
v_mfma_f32_16x16x32_bf16 v[124:127], v[40:43], v[92:95], v[124:127]
ds_read_b128 v[176:179], v6 offset:43008
v_mfma_f32_16x16x32_bf16 v[188:191], v[44:47], v[92:95], v[188:191]
buffer_load_dwordx4 v[64:67], v5, s[20:23], s73 offen sc1
v_mfma_f32_16x16x32_bf16 v[192:195], v[48:51], v[92:95], v[192:195]
ds_read_b128 v[180:183], v6 offset:44032
v_mfma_f32_16x16x32_bf16 v[196:199], v[52:55], v[92:95], v[196:199]
ds_read_b128 v[184:187], v244 offset:40960
v_mfma_f32_16x16x32_bf16 v[200:203], v[56:59], v[92:95], v[200:203]
v_mfma_f32_16x16x32_bf16 v[204:207], v[40:43], v[96:99], v[204:207]
v_mfma_f32_16x16x32_bf16 v[208:211], v[44:47], v[96:99], v[208:211]
v_mfma_f32_16x16x32_bf16 v[212:215], v[48:51], v[96:99], v[212:215]
v_mfma_f32_16x16x32_bf16 v[216:219], v[52:55], v[96:99], v[216:219]
v_mfma_f32_16x16x32_bf16 v[220:223], v[56:59], v[96:99], v[220:223]
v_mfma_f32_16x16x32_bf16 v[224:227], v[40:43], v[100:103], v[224:227]
v_mfma_f32_16x16x32_bf16 v[228:231], v[44:47], v[100:103], v[228:231]
v_mfma_f32_16x16x32_bf16 v[232:235], v[48:51], v[100:103], v[232:235]
v_mfma_f32_16x16x32_bf16 v[236:239], v[52:55], v[100:103], v[236:239]
v_mfma_f32_16x16x32_bf16 v[248:251], v[56:59], v[100:103], v[248:251]
s_waitcnt vmcnt(9) lgkmcnt(0)
v_mfma_f32_16x16x32_bf16 v[104:107], v[72:75], v[16:19], v[104:107]
buffer_load_dwordx4 v[68:71], v2, s[20:23], s74 offen sc1
v_mfma_f32_16x16x32_bf16 v[108:111], v[76:79], v[16:19], v[108:111]
buffer_load_dwordx4 v[92:95], v3, s[20:23], s74 offen sc1
v_mfma_f32_16x16x32_bf16 v[112:115], v[80:83], v[16:19], v[112:115]
buffer_load_dwordx4 v[96:99], v4, s[20:23], s74 offen sc1
v_mfma_f32_16x16x32_bf16 v[116:119], v[84:87], v[16:19], v[116:119]
buffer_load_dwordx4 v[100:103], v5, s[20:23], s74 offen sc1
v_mfma_f32_16x16x32_bf16 v[120:123], v[88:91], v[16:19], v[120:123]
buffer_load_dwordx4 v[40:43], v1, s[20:23], s88 offen offset:0 sc1
v_mfma_f32_16x16x32_bf16 v[124:127], v[72:75], v[20:23], v[124:127]
buffer_load_dwordx4 v[44:47], v1, s[20:23], s88 offen offset:1024 sc1
v_mfma_f32_16x16x32_bf16 v[188:191], v[76:79], v[20:23], v[188:191]
buffer_load_dwordx4 v[48:51], v1, s[20:23], s88 offen offset:2048 sc1
v_mfma_f32_16x16x32_bf16 v[192:195], v[80:83], v[20:23], v[192:195]
buffer_load_dwordx4 v[52:55], v1, s[20:23], s88 offen offset:3072 sc1
v_mfma_f32_16x16x32_bf16 v[196:199], v[84:87], v[20:23], v[196:199]
buffer_load_dwordx4 v[56:59], v243, s[20:23], s88 offen offset:0 sc1
v_mfma_f32_16x16x32_bf16 v[200:203], v[88:91], v[20:23], v[200:203]
v_mfma_f32_16x16x32_bf16 v[204:207], v[72:75], v[24:27], v[204:207]
v_mfma_f32_16x16x32_bf16 v[208:211], v[76:79], v[24:27], v[208:211]
v_mfma_f32_16x16x32_bf16 v[212:215], v[80:83], v[24:27], v[212:215]
v_mfma_f32_16x16x32_bf16 v[216:219], v[84:87], v[24:27], v[216:219]
v_mfma_f32_16x16x32_bf16 v[220:223], v[88:91], v[24:27], v[220:223]
v_mfma_f32_16x16x32_bf16 v[224:227], v[72:75], v[28:31], v[224:227]
v_mfma_f32_16x16x32_bf16 v[228:231], v[76:79], v[28:31], v[228:231]
v_mfma_f32_16x16x32_bf16 v[232:235], v[80:83], v[28:31], v[232:235]
v_mfma_f32_16x16x32_bf16 v[236:239], v[84:87], v[28:31], v[236:239]
v_mfma_f32_16x16x32_bf16 v[248:251], v[88:91], v[28:31], v[248:251]
s_waitcnt vmcnt(9) lgkmcnt(0)
v_mfma_f32_16x16x32_bf16 v[104:107], v[128:131], v[32:35], v[104:107]
buffer_load_dwordx4 v[16:19], v2, s[20:23], s75 offen sc1
v_mfma_f32_16x16x32_bf16 v[108:111], v[132:135], v[32:35], v[108:111]
ds_read_b128 v[72:75], v6 offset:61440
v_mfma_f32_16x16x32_bf16 v[112:115], v[136:139], v[32:35], v[112:115]
buffer_load_dwordx4 v[20:23], v3, s[20:23], s75 offen sc1
v_mfma_f32_16x16x32_bf16 v[116:119], v[140:143], v[32:35], v[116:119]
ds_read_b128 v[76:79], v6 offset:62464
v_mfma_f32_16x16x32_bf16 v[120:123], v[144:147], v[32:35], v[120:123]
buffer_load_dwordx4 v[24:27], v4, s[20:23], s75 offen sc1
v_mfma_f32_16x16x32_bf16 v[124:127], v[128:131], v[36:39], v[124:127]
ds_read_b128 v[80:83], v6 offset:63488
v_mfma_f32_16x16x32_bf16 v[188:191], v[132:135], v[36:39], v[188:191]
buffer_load_dwordx4 v[28:31], v5, s[20:23], s75 offen sc1
v_mfma_f32_16x16x32_bf16 v[192:195], v[136:139], v[36:39], v[192:195]
ds_read_b128 v[84:87], v6 offset:64512
v_mfma_f32_16x16x32_bf16 v[196:199], v[140:143], v[36:39], v[196:199]
ds_read_b128 v[88:91], v244 offset:61440
v_mfma_f32_16x16x32_bf16 v[200:203], v[144:147], v[36:39], v[200:203]
v_mfma_f32_16x16x32_bf16 v[204:207], v[128:131], v[60:63], v[204:207]
v_mfma_f32_16x16x32_bf16 v[208:211], v[132:135], v[60:63], v[208:211]
v_mfma_f32_16x16x32_bf16 v[212:215], v[136:139], v[60:63], v[212:215]
v_mfma_f32_16x16x32_bf16 v[216:219], v[140:143], v[60:63], v[216:219]
v_mfma_f32_16x16x32_bf16 v[220:223], v[144:147], v[60:63], v[220:223]
v_mfma_f32_16x16x32_bf16 v[224:227], v[128:131], v[64:67], v[224:227]
v_mfma_f32_16x16x32_bf16 v[228:231], v[132:135], v[64:67], v[228:231]
v_mfma_f32_16x16x32_bf16 v[232:235], v[136:139], v[64:67], v[232:235]
v_mfma_f32_16x16x32_bf16 v[236:239], v[140:143], v[64:67], v[236:239]
v_mfma_f32_16x16x32_bf16 v[248:251], v[144:147], v[64:67], v[248:251]
s_waitcnt vmcnt(9) lgkmcnt(0)
v_mfma_f32_16x16x32_bf16 v[104:107], v[148:151], v[68:71], v[104:107]
buffer_load_dwordx4 v[32:35], v2, s[20:23], s76 offen sc1
v_mfma_f32_16x16x32_bf16 v[108:111], v[152:155], v[68:71], v[108:111]
buffer_load_dwordx4 v[36:39], v3, s[20:23], s76 offen sc1
v_mfma_f32_16x16x32_bf16 v[112:115], v[156:159], v[68:71], v[112:115]
buffer_load_dwordx4 v[60:63], v4, s[20:23], s76 offen sc1
v_mfma_f32_16x16x32_bf16 v[116:119], v[160:163], v[68:71], v[116:119]
buffer_load_dwordx4 v[64:67], v5, s[20:23], s76 offen sc1
v_mfma_f32_16x16x32_bf16 v[120:123], v[164:167], v[68:71], v[120:123]
v_mfma_f32_16x16x32_bf16 v[124:127], v[148:151], v[92:95], v[124:127]
v_mfma_f32_16x16x32_bf16 v[188:191], v[152:155], v[92:95], v[188:191]
v_mfma_f32_16x16x32_bf16 v[192:195], v[156:159], v[92:95], v[192:195]
v_mfma_f32_16x16x32_bf16 v[196:199], v[160:163], v[92:95], v[196:199]
v_mfma_f32_16x16x32_bf16 v[200:203], v[164:167], v[92:95], v[200:203]
v_mfma_f32_16x16x32_bf16 v[204:207], v[148:151], v[96:99], v[204:207]
v_mfma_f32_16x16x32_bf16 v[208:211], v[152:155], v[96:99], v[208:211]
v_mfma_f32_16x16x32_bf16 v[212:215], v[156:159], v[96:99], v[212:215]
v_mfma_f32_16x16x32_bf16 v[216:219], v[160:163], v[96:99], v[216:219]
v_mfma_f32_16x16x32_bf16 v[220:223], v[164:167], v[96:99], v[220:223]
v_mfma_f32_16x16x32_bf16 v[224:227], v[148:151], v[100:103], v[224:227]
v_mfma_f32_16x16x32_bf16 v[228:231], v[152:155], v[100:103], v[228:231]
v_mfma_f32_16x16x32_bf16 v[232:235], v[156:159], v[100:103], v[232:235]
v_mfma_f32_16x16x32_bf16 v[236:239], v[160:163], v[100:103], v[236:239]
v_mfma_f32_16x16x32_bf16 v[248:251], v[164:167], v[100:103], v[248:251]
s_waitcnt vmcnt(4) lgkmcnt(0)
v_mfma_f32_16x16x32_bf16 v[104:107], v[168:171], v[16:19], v[104:107]
buffer_load_dwordx4 v[68:71], v2, s[20:23], s77 offen sc1
v_mfma_f32_16x16x32_bf16 v[108:111], v[172:175], v[16:19], v[108:111]
buffer_load_dwordx4 v[92:95], v3, s[20:23], s77 offen sc1
v_mfma_f32_16x16x32_bf16 v[112:115], v[176:179], v[16:19], v[112:115]
buffer_load_dwordx4 v[96:99], v4, s[20:23], s77 offen sc1
v_mfma_f32_16x16x32_bf16 v[116:119], v[180:183], v[16:19], v[116:119]
buffer_load_dwordx4 v[100:103], v5, s[20:23], s77 offen sc1
v_mfma_f32_16x16x32_bf16 v[120:123], v[184:187], v[16:19], v[120:123]
buffer_load_dword v9, v8, s[20:23], s41 offen sc1
v_mfma_f32_16x16x32_bf16 v[124:127], v[168:171], v[20:23], v[124:127]
buffer_load_dwordx4 v[148:151], v240, s[12:15], s43 offen
v_mfma_f32_16x16x32_bf16 v[188:191], v[172:175], v[20:23], v[188:191]
buffer_load_dwordx4 v[152:155], v241, s[12:15], s43 offen
v_mfma_f32_16x16x32_bf16 v[192:195], v[176:179], v[20:23], v[192:195]
buffer_load_dwordx4 v[156:159], v245, s[12:15], s43 offen
v_mfma_f32_16x16x32_bf16 v[196:199], v[180:183], v[20:23], v[196:199]
v_mfma_f32_16x16x32_bf16 v[200:203], v[184:187], v[20:23], v[200:203]
v_mfma_f32_16x16x32_bf16 v[204:207], v[168:171], v[24:27], v[204:207]
v_mfma_f32_16x16x32_bf16 v[208:211], v[172:175], v[24:27], v[208:211]
v_mfma_f32_16x16x32_bf16 v[212:215], v[176:179], v[24:27], v[212:215]
v_mfma_f32_16x16x32_bf16 v[216:219], v[180:183], v[24:27], v[216:219]
v_mfma_f32_16x16x32_bf16 v[220:223], v[184:187], v[24:27], v[220:223]
v_mfma_f32_16x16x32_bf16 v[224:227], v[168:171], v[28:31], v[224:227]
v_mfma_f32_16x16x32_bf16 v[228:231], v[172:175], v[28:31], v[228:231]
v_mfma_f32_16x16x32_bf16 v[232:235], v[176:179], v[28:31], v[232:235]
v_mfma_f32_16x16x32_bf16 v[236:239], v[180:183], v[28:31], v[236:239]
v_mfma_f32_16x16x32_bf16 v[248:251], v[184:187], v[28:31], v[248:251]
s_waitcnt vmcnt(8) lgkmcnt(0)
v_mfma_f32_16x16x32_bf16 v[104:107], v[40:43], v[32:35], v[104:107]
v_mfma_f32_16x16x32_bf16 v[108:111], v[44:47], v[32:35], v[108:111]
v_mfma_f32_16x16x32_bf16 v[112:115], v[48:51], v[32:35], v[112:115]
v_mfma_f32_16x16x32_bf16 v[116:119], v[52:55], v[32:35], v[116:119]
v_mfma_f32_16x16x32_bf16 v[120:123], v[56:59], v[32:35], v[120:123]
v_mfma_f32_16x16x32_bf16 v[124:127], v[40:43], v[36:39], v[124:127]
v_mfma_f32_16x16x32_bf16 v[188:191], v[44:47], v[36:39], v[188:191]
v_mfma_f32_16x16x32_bf16 v[192:195], v[48:51], v[36:39], v[192:195]
v_mfma_f32_16x16x32_bf16 v[196:199], v[52:55], v[36:39], v[196:199]
v_mfma_f32_16x16x32_bf16 v[200:203], v[56:59], v[36:39], v[200:203]
v_mfma_f32_16x16x32_bf16 v[204:207], v[40:43], v[60:63], v[204:207]
v_mfma_f32_16x16x32_bf16 v[208:211], v[44:47], v[60:63], v[208:211]
v_mfma_f32_16x16x32_bf16 v[212:215], v[48:51], v[60:63], v[212:215]
v_mfma_f32_16x16x32_bf16 v[216:219], v[52:55], v[60:63], v[216:219]
v_mfma_f32_16x16x32_bf16 v[220:223], v[56:59], v[60:63], v[220:223]
v_mfma_f32_16x16x32_bf16 v[224:227], v[40:43], v[64:67], v[224:227]
v_mfma_f32_16x16x32_bf16 v[228:231], v[44:47], v[64:67], v[228:231]
v_mfma_f32_16x16x32_bf16 v[232:235], v[48:51], v[64:67], v[232:235]
v_mfma_f32_16x16x32_bf16 v[236:239], v[52:55], v[64:67], v[236:239]
v_mfma_f32_16x16x32_bf16 v[248:251], v[56:59], v[64:67], v[248:251]
s_waitcnt vmcnt(0) lgkmcnt(0)
v_cmp_ne_u32 vcc, 1, v9
s_mov_b32 s91, 0
s_cbranch_vccnz L_y_late
s_add_u32 s33, s40, 0
buffer_load_dwordx2 v[168:169], v12, s[20:23], s33 offen sc1
s_add_u32 s33, s40, 65536
buffer_load_dwordx2 v[170:171], v12, s[20:23], s33 offen sc1
s_add_u32 s33, s40, 131072
buffer_load_dwordx2 v[172:173], v12, s[20:23], s33 offen sc1
s_add_u32 s33, s40, 196608
buffer_load_dwordx2 v[174:175], v12, s[20:23], s33 offen sc1
s_add_u32 s33, s40, 262144
buffer_load_dwordx2 v[176:177], v12, s[20:23], s33 offen sc1
s_mov_b32 s91, 1
L_y_late:
v_mfma_f32_16x16x32_bf16 v[124:127], v[72:75], v[92:95], v[124:127]

v_mfma_f32_16x16x32_bf16 v[188:191], v[76:79], v[92:95], v[188:191]

v_mfma_f32_16x16x32_bf16 v[192:195], v[80:83], v[92:95], v[192:195]

v_mfma_f32_16x16x32_bf16 v[196:199], v[84:87], v[92:95], v[196:199]

v_mfma_f32_16x16x32_bf16 v[200:203], v[88:91], v[92:95], v[200:203]
s_nop 3
ds_write_b128 v7, v[124:127] offset:0
v_mfma_f32_16x16x32_bf16 v[204:207], v[72:75], v[96:99], v[204:207]
ds_write_b128 v7, v[188:191] offset:1024
v_mfma_f32_16x16x32_bf16 v[208:211], v[76:79], v[96:99], v[208:211]
ds_write_b128 v7, v[192:195] offset:2048
v_mfma_f32_16x16x32_bf16 v[212:215], v[80:83], v[96:99], v[212:215]
ds_write_b128 v7, v[196:199] offset:3072
v_mfma_f32_16x16x32_bf16 v[216:219], v[84:87], v[96:99], v[216:219]
ds_write_b128 v7, v[200:203] offset:4096
v_mfma_f32_16x16x32_bf16 v[220:223], v[88:91], v[96:99], v[220:223]
ds_write_b128 v7, v[204:207] offset:20480
v_mfma_f32_16x16x32_bf16 v[224:227], v[72:75], v[100:103], v[224:227]
ds_write_b128 v7, v[208:211] offset:21504
v_mfma_f32_16x16x32_bf16 v[228:231], v[76:79], v[100:103], v[228:231]
ds_write_b128 v7, v[212:215] offset:22528
v_mfma_f32_16x16x32_bf16 v[232:235], v[80:83], v[100:103], v[232:235]
ds_write_b128 v7, v[216:219] offset:23552
v_mfma_f32_16x16x32_bf16 v[236:239], v[84:87], v[100:103], v[236:239]
ds_write_b128 v7, v[220:223] offset:24576
v_mfma_f32_16x16x32_bf16 v[248:251], v[88:91], v[100:103], v[248:251]
ds_write_b128 v7, v[224:227] offset:40960
v_mfma_f32_16x16x32_bf16 v[104:107], v[72:75], v[68:71], v[104:107]
ds_write_b128 v7, v[228:231] offset:41984
v_mfma_f32_16x16x32_bf16 v[108:111], v[76:79], v[68:71], v[108:111]
ds_write_b128 v7, v[232:235] offset:43008
v_mfma_f32_16x16x32_bf16 v[112:115], v[80:83], v[68:71], v[112:115]
ds_write_b128 v7, v[236:239] offset:44032
v_mfma_f32_16x16x32_bf16 v[116:119], v[84:87], v[68:71], v[116:119]
ds_write_b128 v7, v[248:251] offset:45056
v_mfma_f32_16x16x32_bf16 v[120:123], v[88:91], v[68:71], v[120:123]
s_xor_b32 s33, s24, 1
s_mul_i32 s33, s33, 5120
v_add_u32 v2, s33, v1
s_xor_b32 s33, s24, 2
s_mul_i32 s33, s33, 5120
v_add_u32 v3, s33, v1
s_xor_b32 s33, s24, 3
s_mul_i32 s33, s33, 5120
v_add_u32 v4, s33, v1
v_mul_u32_u24 v8, 160, v10
v_add_u32 v8, s65, v8
v_lshl_add_u32 v9, v11, 3, v8
v_add_u32 v9, 61440, v9
s_waitcnt lgkmcnt(0)
s_barrier
ds_read_b128 v[124:127], v2 offset:0
ds_read_b128 v[188:191], v2 offset:1024
ds_read_b128 v[192:195], v2 offset:2048
ds_read_b128 v[196:199], v2 offset:3072
ds_read_b128 v[200:203], v2 offset:4096
ds_read_b128 v[204:207], v3 offset:20480
ds_read_b128 v[208:211], v3 offset:21504
ds_read_b128 v[212:215], v3 offset:22528
ds_read_b128 v[216:219], v3 offset:23552
ds_read_b128 v[220:223], v3 offset:24576
ds_read_b128 v[224:227], v4 offset:40960
ds_read_b128 v[228:231], v4 offset:41984
ds_read_b128 v[232:235], v4 offset:43008
ds_read_b128 v[236:239], v4 offset:44032
ds_read_b128 v[248:251], v4 offset:45056
v_lshlrev_b32 v16, 16, v148
v_and_b32 v17, 0xffff0000, v148
v_lshlrev_b32 v18, 16, v149
v_and_b32 v19, 0xffff0000, v149
v_lshlrev_b32 v20, 16, v150
v_and_b32 v21, 0xffff0000, v150
v_lshlrev_b32 v22, 16, v151
v_and_b32 v23, 0xffff0000, v151
v_lshlrev_b32 v24, 16, v152
v_and_b32 v25, 0xffff0000, v152
v_lshlrev_b32 v26, 16, v153
v_and_b32 v27, 0xffff0000, v153
v_lshlrev_b32 v28, 16, v154
v_and_b32 v29, 0xffff0000, v154
v_lshlrev_b32 v30, 16, v155
v_and_b32 v31, 0xffff0000, v155
v_lshlrev_b32 v32, 16, v156
v_and_b32 v33, 0xffff0000, v156
v_lshlrev_b32 v34, 16, v157
v_and_b32 v35, 0xffff0000, v157
v_lshlrev_b32 v36, 16, v158
v_and_b32 v37, 0xffff0000, v158
v_lshlrev_b32 v38, 16, v159
v_and_b32 v39, 0xffff0000, v159
s_waitcnt lgkmcnt(14)
v_pk_add_f32 v[104:105], v[104:105], v[124:125]
v_pk_add_f32 v[106:107], v[106:107], v[126:127]
s_waitcnt lgkmcnt(13)
v_pk_add_f32 v[108:109], v[108:109], v[188:189]
v_pk_add_f32 v[110:111], v[110:111], v[190:191]
s_waitcnt lgkmcnt(12)
v_pk_add_f32 v[112:113], v[112:113], v[192:193]
v_pk_add_f32 v[114:115], v[114:115], v[194:195]
s_waitcnt lgkmcnt(11)
v_pk_add_f32 v[116:117], v[116:117], v[196:197]
v_pk_add_f32 v[118:119], v[118:119], v[198:199]
s_waitcnt lgkmcnt(10)
v_pk_add_f32 v[120:121], v[120:121], v[200:201]
v_pk_add_f32 v[122:123], v[122:123], v[202:203]
s_waitcnt lgkmcnt(9)
v_pk_add_f32 v[104:105], v[104:105], v[204:205]
v_pk_add_f32 v[106:107], v[106:107], v[206:207]
s_waitcnt lgkmcnt(8)
v_pk_add_f32 v[108:109], v[108:109], v[208:209]
v_pk_add_f32 v[110:111], v[110:111], v[210:211]
s_waitcnt lgkmcnt(7)
v_pk_add_f32 v[112:113], v[112:113], v[212:213]
v_pk_add_f32 v[114:115], v[114:115], v[214:215]
s_waitcnt lgkmcnt(6)
v_pk_add_f32 v[116:117], v[116:117], v[216:217]
v_pk_add_f32 v[118:119], v[118:119], v[218:219]
s_waitcnt lgkmcnt(5)
v_pk_add_f32 v[120:121], v[120:121], v[220:221]
v_pk_add_f32 v[122:123], v[122:123], v[222:223]
s_waitcnt lgkmcnt(4)
v_pk_add_f32 v[104:105], v[104:105], v[224:225]
v_pk_add_f32 v[106:107], v[106:107], v[226:227]
s_waitcnt lgkmcnt(3)
v_pk_add_f32 v[108:109], v[108:109], v[228:229]
v_pk_add_f32 v[110:111], v[110:111], v[230:231]
s_waitcnt lgkmcnt(2)
v_pk_add_f32 v[112:113], v[112:113], v[232:233]
v_pk_add_f32 v[114:115], v[114:115], v[234:235]
s_waitcnt lgkmcnt(1)
v_pk_add_f32 v[116:117], v[116:117], v[236:237]
v_pk_add_f32 v[118:119], v[118:119], v[238:239]
s_waitcnt lgkmcnt(0)
v_pk_add_f32 v[120:121], v[120:121], v[248:249]
v_pk_add_f32 v[122:123], v[122:123], v[250:251]
s_cmp_eq_u32 s91, 1
s_cbranch_scc1 L_y_have
v_min_u32 v2, 19, v0
v_lshlrev_b32 v2, 7, v2
s_mov_b32 s42, 0
buffer_load_dword v3, v2, s[20:23], s41 offen sc1
s_waitcnt vmcnt(0)
L_y_p:
v_cmp_ne_u32 vcc, 1, v3
s_cbranch_vccz L_y_ok
s_add_u32 s42, s42, 1
s_cmp_gt_u32 s42, 20000
s_cbranch_scc1 L_y_ok
s_sleep 4
buffer_load_dword v3, v2, s[20:23], s41 offen sc1
s_waitcnt vmcnt(0)
s_branch L_y_p
L_y_ok:
s_add_u32 s33, s40, 0
buffer_load_dwordx2 v[168:169], v12, s[20:23], s33 offen sc1
s_add_u32 s33, s40, 65536
buffer_load_dwordx2 v[170:171], v12, s[20:23], s33 offen sc1
s_add_u32 s33, s40, 131072
buffer_load_dwordx2 v[172:173], v12, s[20:23], s33 offen sc1
s_add_u32 s33, s40, 196608
buffer_load_dwordx2 v[174:175], v12, s[20:23], s33 offen sc1
s_add_u32 s33, s40, 262144
buffer_load_dwordx2 v[176:177], v12, s[20:23], s33 offen sc1
L_y_have:
s_waitcnt vmcnt(0)
v_lshlrev_b32 v14, 16, v168
v_and_b32 v15, 0xffff0000, v168
v_pk_add_f32 v[104:105], v[104:105], v[14:15]
v_cvt_pk_bf16_f32 v60, v104, v105
v_lshlrev_b32 v14, 16, v169
v_and_b32 v15, 0xffff0000, v169
v_pk_add_f32 v[106:107], v[106:107], v[14:15]
v_cvt_pk_bf16_f32 v61, v106, v107
v_lshlrev_b32 v14, 16, v170
v_and_b32 v15, 0xffff0000, v170
v_pk_add_f32 v[108:109], v[108:109], v[14:15]
v_cvt_pk_bf16_f32 v62, v108, v109
v_lshlrev_b32 v14, 16, v171
v_and_b32 v15, 0xffff0000, v171
v_pk_add_f32 v[110:111], v[110:111], v[14:15]
v_cvt_pk_bf16_f32 v63, v110, v111
v_lshlrev_b32 v14, 16, v172
v_and_b32 v15, 0xffff0000, v172
v_pk_add_f32 v[112:113], v[112:113], v[14:15]
v_cvt_pk_bf16_f32 v64, v112, v113
v_lshlrev_b32 v14, 16, v173
v_and_b32 v15, 0xffff0000, v173
v_pk_add_f32 v[114:115], v[114:115], v[14:15]
v_cvt_pk_bf16_f32 v65, v114, v115
v_lshlrev_b32 v14, 16, v174
v_and_b32 v15, 0xffff0000, v174
v_pk_add_f32 v[116:117], v[116:117], v[14:15]
v_cvt_pk_bf16_f32 v66, v116, v117
v_lshlrev_b32 v14, 16, v175
v_and_b32 v15, 0xffff0000, v175
v_pk_add_f32 v[118:119], v[118:119], v[14:15]
v_cvt_pk_bf16_f32 v67, v118, v119
v_lshlrev_b32 v14, 16, v176
v_and_b32 v15, 0xffff0000, v176
v_pk_add_f32 v[120:121], v[120:121], v[14:15]
v_cvt_pk_bf16_f32 v68, v120, v121
v_lshlrev_b32 v14, 16, v177
v_and_b32 v15, 0xffff0000, v177
v_pk_add_f32 v[122:123], v[122:123], v[14:15]
v_cvt_pk_bf16_f32 v69, v122, v123
ds_write2_b64 v9, v[60:61], v[62:63] offset0:0 offset1:4
ds_write2_b64 v9, v[64:65], v[66:67] offset0:8 offset1:12
ds_write_b64 v9, v[68:69] offset:128
ds_read_b128 v[92:95], v7 offset:61440
ds_read_b128 v[96:99], v7 offset:62464
ds_read_b128 v[100:103], v7 offset:63488
s_waitcnt lgkmcnt(2)
v_lshlrev_b32 v14, 16, v92
v_and_b32 v15, 0xffff0000, v92
v_pk_add_f32 v[14:15], v[14:15], v[16:17]
v_cvt_pk_bf16_f32 v92, v14, v15
v_lshlrev_b32 v14, 16, v93
v_and_b32 v15, 0xffff0000, v93
v_pk_add_f32 v[14:15], v[14:15], v[18:19]
v_cvt_pk_bf16_f32 v93, v14, v15
v_lshlrev_b32 v14, 16, v94
v_and_b32 v15, 0xffff0000, v94
v_pk_add_f32 v[14:15], v[14:15], v[20:21]
v_cvt_pk_bf16_f32 v94, v14, v15
v_lshlrev_b32 v14, 16, v95
v_and_b32 v15, 0xffff0000, v95
v_pk_add_f32 v[14:15], v[14:15], v[22:23]
v_cvt_pk_bf16_f32 v95, v14, v15
buffer_store_dwordx4 v[92:95], v240, s[56:59], s43 offen
s_waitcnt lgkmcnt(1)
v_lshlrev_b32 v14, 16, v96
v_and_b32 v15, 0xffff0000, v96
v_pk_add_f32 v[14:15], v[14:15], v[24:25]
v_cvt_pk_bf16_f32 v96, v14, v15
v_lshlrev_b32 v14, 16, v97
v_and_b32 v15, 0xffff0000, v97
v_pk_add_f32 v[14:15], v[14:15], v[26:27]
v_cvt_pk_bf16_f32 v97, v14, v15
v_lshlrev_b32 v14, 16, v98
v_and_b32 v15, 0xffff0000, v98
v_pk_add_f32 v[14:15], v[14:15], v[28:29]
v_cvt_pk_bf16_f32 v98, v14, v15
v_lshlrev_b32 v14, 16, v99
v_and_b32 v15, 0xffff0000, v99
v_pk_add_f32 v[14:15], v[14:15], v[30:31]
v_cvt_pk_bf16_f32 v99, v14, v15
buffer_store_dwordx4 v[96:99], v241, s[56:59], s43 offen
s_waitcnt lgkmcnt(0)
v_lshlrev_b32 v14, 16, v100
v_and_b32 v15, 0xffff0000, v100
v_pk_add_f32 v[14:15], v[14:15], v[32:33]
v_cvt_pk_bf16_f32 v100, v14, v15
v_lshlrev_b32 v14, 16, v101
v_and_b32 v15, 0xffff0000, v101
v_pk_add_f32 v[14:15], v[14:15], v[34:35]
v_cvt_pk_bf16_f32 v101, v14, v15
v_lshlrev_b32 v14, 16, v102
v_and_b32 v15, 0xffff0000, v102
v_pk_add_f32 v[14:15], v[14:15], v[36:37]
v_cvt_pk_bf16_f32 v102, v14, v15
v_lshlrev_b32 v14, 16, v103
v_and_b32 v15, 0xffff0000, v103
v_pk_add_f32 v[14:15], v[14:15], v[38:39]
v_cvt_pk_bf16_f32 v103, v14, v15
buffer_store_dwordx4 v[100:103], v245, s[56:59], s43 offen
s_endpgm
L_help:
s_cmp_lt_u32 s2, 160
s_cbranch_scc1 L_kc
s_cmp_ge_u32 s2, 224
s_cbranch_scc1 L_pw
s_load_dwordx2 s[4:5], s[0:1], 0
s_load_dwordx2 s[6:7], s[0:1], 96
s_load_dwordx4 s[44:47], s[0:1], 112
s_sub_u32 s25, s2, 160
s_and_b32 s33, s25, 1
s_lshl_b32 s33, s33, 5
s_lshr_b32 s25, s25, 1
s_add_u32 s25, s25, s33
s_setprio 3
v_lshrrev_b32 v4, 3, v0
s_lshl_b32 s33, s24, 3
v_add_u32 v4, s33, v4
v_mul_u32_u24 v5, 1280, v4
v_and_b32 v6, 7, v0
v_lshl_add_u32 v1, v6, 4, v5
s_mul_i32 s26, s25, 40960
s_waitcnt lgkmcnt(0)
s_mov_b32 s12, s4
s_mov_b32 s13, s5
s_mov_b32 s14, 2621440
s_mov_b32 s15, 0x20000
s_mov_b32 s20, s46
s_mov_b32 s21, s47
s_mov_b32 s22, 33554432
s_mov_b32 s23, 0x20000
s_mov_b32 s48, s44
s_mov_b32 s49, s45
s_mov_b32 s50, 256
s_mov_b32 s51, 0x20000
buffer_load_dwordx4 v[16:19], v1, s[12:15], s26 offen offset:0
buffer_load_dwordx4 v[20:23], v1, s[12:15], s26 offen offset:128
buffer_load_dwordx4 v[24:27], v1, s[12:15], s26 offen offset:256
buffer_load_dwordx4 v[28:31], v1, s[12:15], s26 offen offset:384
buffer_load_dwordx4 v[32:35], v1, s[12:15], s26 offen offset:512
buffer_load_dwordx4 v[36:39], v1, s[12:15], s26 offen offset:640
buffer_load_dwordx4 v[40:43], v1, s[12:15], s26 offen offset:768
buffer_load_dwordx4 v[44:47], v1, s[12:15], s26 offen offset:896
buffer_load_dwordx4 v[48:51], v1, s[12:15], s26 offen offset:1024
buffer_load_dwordx4 v[52:55], v1, s[12:15], s26 offen offset:1152
v_mov_b32 v12, 0
v_lshlrev_b32 v13, 7, v0
s_mul_i32 s33, s25, 2688
s_add_u32 s33, s33, 14745600
s_cmp_eq_u32 s24, 0
s_cselect_b32 s34, 21, 1
v_cmp_gt_u32 vcc, s34, v0
s_nop 0
s_and_saveexec_b64 s[34:35], vcc
buffer_store_dword v12, v13, s[20:23], s33 offen sc1
s_mov_b64 exec, s[34:35]
v_and_b32 v7, 3, v4
s_lshl_b32 s33, s24, 2
v_or_b32 v7, s33, v7
v_xor_b32 v6, v6, v7
v_lshl_add_u32 v2, v6, 4, v5
v_xor_b32 v3, 128, v2
v_mov_b32 v8, 0
v_mov_b32 v9, 0
s_waitcnt vmcnt(10)
v_lshlrev_b32 v56, 16, v16
v_and_b32 v57, 0xffff0000, v16
v_add_f32 v8, v8, v56
v_add_f32 v9, v9, v57
v_lshlrev_b32 v58, 16, v17
v_and_b32 v59, 0xffff0000, v17
v_add_f32 v8, v8, v58
v_add_f32 v9, v9, v59
v_lshlrev_b32 v60, 16, v18
v_and_b32 v61, 0xffff0000, v18
v_add_f32 v8, v8, v60
v_add_f32 v9, v9, v61
v_lshlrev_b32 v62, 16, v19
v_and_b32 v63, 0xffff0000, v19
v_add_f32 v8, v8, v62
v_add_f32 v9, v9, v63
s_waitcnt vmcnt(9)
v_lshlrev_b32 v64, 16, v20
v_and_b32 v65, 0xffff0000, v20
v_add_f32 v8, v8, v64
v_add_f32 v9, v9, v65
v_lshlrev_b32 v66, 16, v21
v_and_b32 v67, 0xffff0000, v21
v_add_f32 v8, v8, v66
v_add_f32 v9, v9, v67
v_lshlrev_b32 v68, 16, v22
v_and_b32 v69, 0xffff0000, v22
v_add_f32 v8, v8, v68
v_add_f32 v9, v9, v69
v_lshlrev_b32 v70, 16, v23
v_and_b32 v71, 0xffff0000, v23
v_add_f32 v8, v8, v70
v_add_f32 v9, v9, v71
s_waitcnt vmcnt(8)
v_lshlrev_b32 v72, 16, v24
v_and_b32 v73, 0xffff0000, v24
v_add_f32 v8, v8, v72
v_add_f32 v9, v9, v73
v_lshlrev_b32 v74, 16, v25
v_and_b32 v75, 0xffff0000, v25
v_add_f32 v8, v8, v74
v_add_f32 v9, v9, v75
v_lshlrev_b32 v76, 16, v26
v_and_b32 v77, 0xffff0000, v26
v_add_f32 v8, v8, v76
v_add_f32 v9, v9, v77
v_lshlrev_b32 v78, 16, v27
v_and_b32 v79, 0xffff0000, v27
v_add_f32 v8, v8, v78
v_add_f32 v9, v9, v79
s_waitcnt vmcnt(7)
v_lshlrev_b32 v80, 16, v28
v_and_b32 v81, 0xffff0000, v28
v_add_f32 v8, v8, v80
v_add_f32 v9, v9, v81
v_lshlrev_b32 v82, 16, v29
v_and_b32 v83, 0xffff0000, v29
v_add_f32 v8, v8, v82
v_add_f32 v9, v9, v83
v_lshlrev_b32 v84, 16, v30
v_and_b32 v85, 0xffff0000, v30
v_add_f32 v8, v8, v84
v_add_f32 v9, v9, v85
v_lshlrev_b32 v86, 16, v31
v_and_b32 v87, 0xffff0000, v31
v_add_f32 v8, v8, v86
v_add_f32 v9, v9, v87
s_waitcnt vmcnt(6)
v_lshlrev_b32 v88, 16, v32
v_and_b32 v89, 0xffff0000, v32
v_add_f32 v8, v8, v88
v_add_f32 v9, v9, v89
v_lshlrev_b32 v90, 16, v33
v_and_b32 v91, 0xffff0000, v33
v_add_f32 v8, v8, v90
v_add_f32 v9, v9, v91
v_lshlrev_b32 v92, 16, v34
v_and_b32 v93, 0xffff0000, v34
v_add_f32 v8, v8, v92
v_add_f32 v9, v9, v93
v_lshlrev_b32 v94, 16, v35
v_and_b32 v95, 0xffff0000, v35
v_add_f32 v8, v8, v94
v_add_f32 v9, v9, v95
s_waitcnt vmcnt(5)
v_lshlrev_b32 v96, 16, v36
v_and_b32 v97, 0xffff0000, v36
v_add_f32 v8, v8, v96
v_add_f32 v9, v9, v97
v_lshlrev_b32 v98, 16, v37
v_and_b32 v99, 0xffff0000, v37
v_add_f32 v8, v8, v98
v_add_f32 v9, v9, v99
v_lshlrev_b32 v100, 16, v38
v_and_b32 v101, 0xffff0000, v38
v_add_f32 v8, v8, v100
v_add_f32 v9, v9, v101
v_lshlrev_b32 v102, 16, v39
v_and_b32 v103, 0xffff0000, v39
v_add_f32 v8, v8, v102
v_add_f32 v9, v9, v103
s_waitcnt vmcnt(4)
v_lshlrev_b32 v104, 16, v40
v_and_b32 v105, 0xffff0000, v40
v_add_f32 v8, v8, v104
v_add_f32 v9, v9, v105
v_lshlrev_b32 v106, 16, v41
v_and_b32 v107, 0xffff0000, v41
v_add_f32 v8, v8, v106
v_add_f32 v9, v9, v107
v_lshlrev_b32 v108, 16, v42
v_and_b32 v109, 0xffff0000, v42
v_add_f32 v8, v8, v108
v_add_f32 v9, v9, v109
v_lshlrev_b32 v110, 16, v43
v_and_b32 v111, 0xffff0000, v43
v_add_f32 v8, v8, v110
v_add_f32 v9, v9, v111
s_waitcnt vmcnt(3)
v_lshlrev_b32 v112, 16, v44
v_and_b32 v113, 0xffff0000, v44
v_add_f32 v8, v8, v112
v_add_f32 v9, v9, v113
v_lshlrev_b32 v114, 16, v45
v_and_b32 v115, 0xffff0000, v45
v_add_f32 v8, v8, v114
v_add_f32 v9, v9, v115
v_lshlrev_b32 v116, 16, v46
v_and_b32 v117, 0xffff0000, v46
v_add_f32 v8, v8, v116
v_add_f32 v9, v9, v117
v_lshlrev_b32 v118, 16, v47
v_and_b32 v119, 0xffff0000, v47
v_add_f32 v8, v8, v118
v_add_f32 v9, v9, v119
s_waitcnt vmcnt(2)
v_lshlrev_b32 v120, 16, v48
v_and_b32 v121, 0xffff0000, v48
v_add_f32 v8, v8, v120
v_add_f32 v9, v9, v121
v_lshlrev_b32 v122, 16, v49
v_and_b32 v123, 0xffff0000, v49
v_add_f32 v8, v8, v122
v_add_f32 v9, v9, v123
v_lshlrev_b32 v124, 16, v50
v_and_b32 v125, 0xffff0000, v50
v_add_f32 v8, v8, v124
v_add_f32 v9, v9, v125
v_lshlrev_b32 v126, 16, v51
v_and_b32 v127, 0xffff0000, v51
v_add_f32 v8, v8, v126
v_add_f32 v9, v9, v127
s_waitcnt vmcnt(1)
v_lshlrev_b32 v128, 16, v52
v_and_b32 v129, 0xffff0000, v52
v_add_f32 v8, v8, v128
v_add_f32 v9, v9, v129
v_lshlrev_b32 v130, 16, v53
v_and_b32 v131, 0xffff0000, v53
v_add_f32 v8, v8, v130
v_add_f32 v9, v9, v131
v_lshlrev_b32 v132, 16, v54
v_and_b32 v133, 0xffff0000, v54
v_add_f32 v8, v8, v132
v_add_f32 v9, v9, v133
v_lshlrev_b32 v134, 16, v55
v_and_b32 v135, 0xffff0000, v55
v_add_f32 v8, v8, v134
v_add_f32 v9, v9, v135
v_add_f32 v8, v8, v9
s_nop 1
v_add_f32_dpp v8, v8, v8 quad_perm:[1,0,3,2] row_mask:0xf bank_mask:0xf
s_nop 1
v_add_f32_dpp v8, v8, v8 quad_perm:[2,3,0,1] row_mask:0xf bank_mask:0xf
s_nop 1
v_add_f32_dpp v8, v8, v8 row_half_mirror row_mask:0xf bank_mask:0xf
v_mul_f32 v10, 0xbacccccd, v8
v_mul_f32 v11, 0xbacccccd, v8
v_mov_b32 v8, 0
v_mov_b32 v9, 0
v_add_f32 v12, v56, v10
v_add_f32 v13, v57, v10
v_fmac_f32 v8, v12, v12
v_fmac_f32 v9, v13, v13
v_add_f32 v14, v58, v10
v_add_f32 v15, v59, v10
v_fmac_f32 v8, v14, v14
v_fmac_f32 v9, v15, v15
v_add_f32 v12, v60, v10
v_add_f32 v13, v61, v10
v_fmac_f32 v8, v12, v12
v_fmac_f32 v9, v13, v13
v_add_f32 v14, v62, v10
v_add_f32 v15, v63, v10
v_fmac_f32 v8, v14, v14
v_fmac_f32 v9, v15, v15
v_add_f32 v12, v64, v10
v_add_f32 v13, v65, v10
v_fmac_f32 v8, v12, v12
v_fmac_f32 v9, v13, v13
v_add_f32 v14, v66, v10
v_add_f32 v15, v67, v10
v_fmac_f32 v8, v14, v14
v_fmac_f32 v9, v15, v15
v_add_f32 v12, v68, v10
v_add_f32 v13, v69, v10
v_fmac_f32 v8, v12, v12
v_fmac_f32 v9, v13, v13
v_add_f32 v14, v70, v10
v_add_f32 v15, v71, v10
v_fmac_f32 v8, v14, v14
v_fmac_f32 v9, v15, v15
v_add_f32 v12, v72, v10
v_add_f32 v13, v73, v10
v_fmac_f32 v8, v12, v12
v_fmac_f32 v9, v13, v13
v_add_f32 v14, v74, v10
v_add_f32 v15, v75, v10
v_fmac_f32 v8, v14, v14
v_fmac_f32 v9, v15, v15
v_add_f32 v12, v76, v10
v_add_f32 v13, v77, v10
v_fmac_f32 v8, v12, v12
v_fmac_f32 v9, v13, v13
v_add_f32 v14, v78, v10
v_add_f32 v15, v79, v10
v_fmac_f32 v8, v14, v14
v_fmac_f32 v9, v15, v15
v_add_f32 v12, v80, v10
v_add_f32 v13, v81, v10
v_fmac_f32 v8, v12, v12
v_fmac_f32 v9, v13, v13
v_add_f32 v14, v82, v10
v_add_f32 v15, v83, v10
v_fmac_f32 v8, v14, v14
v_fmac_f32 v9, v15, v15
v_add_f32 v12, v84, v10
v_add_f32 v13, v85, v10
v_fmac_f32 v8, v12, v12
v_fmac_f32 v9, v13, v13
v_add_f32 v14, v86, v10
v_add_f32 v15, v87, v10
v_fmac_f32 v8, v14, v14
v_fmac_f32 v9, v15, v15
v_add_f32 v12, v88, v10
v_add_f32 v13, v89, v10
v_fmac_f32 v8, v12, v12
v_fmac_f32 v9, v13, v13
v_add_f32 v14, v90, v10
v_add_f32 v15, v91, v10
v_fmac_f32 v8, v14, v14
v_fmac_f32 v9, v15, v15
v_add_f32 v12, v92, v10
v_add_f32 v13, v93, v10
v_fmac_f32 v8, v12, v12
v_fmac_f32 v9, v13, v13
v_add_f32 v14, v94, v10
v_add_f32 v15, v95, v10
v_fmac_f32 v8, v14, v14
v_fmac_f32 v9, v15, v15
v_add_f32 v12, v96, v10
v_add_f32 v13, v97, v10
v_fmac_f32 v8, v12, v12
v_fmac_f32 v9, v13, v13
v_add_f32 v14, v98, v10
v_add_f32 v15, v99, v10
v_fmac_f32 v8, v14, v14
v_fmac_f32 v9, v15, v15
v_add_f32 v12, v100, v10
v_add_f32 v13, v101, v10
v_fmac_f32 v8, v12, v12
v_fmac_f32 v9, v13, v13
v_add_f32 v14, v102, v10
v_add_f32 v15, v103, v10
v_fmac_f32 v8, v14, v14
v_fmac_f32 v9, v15, v15
v_add_f32 v12, v104, v10
v_add_f32 v13, v105, v10
v_fmac_f32 v8, v12, v12
v_fmac_f32 v9, v13, v13
v_add_f32 v14, v106, v10
v_add_f32 v15, v107, v10
v_fmac_f32 v8, v14, v14
v_fmac_f32 v9, v15, v15
v_add_f32 v12, v108, v10
v_add_f32 v13, v109, v10
v_fmac_f32 v8, v12, v12
v_fmac_f32 v9, v13, v13
v_add_f32 v14, v110, v10
v_add_f32 v15, v111, v10
v_fmac_f32 v8, v14, v14
v_fmac_f32 v9, v15, v15
v_add_f32 v12, v112, v10
v_add_f32 v13, v113, v10
v_fmac_f32 v8, v12, v12
v_fmac_f32 v9, v13, v13
v_add_f32 v14, v114, v10
v_add_f32 v15, v115, v10
v_fmac_f32 v8, v14, v14
v_fmac_f32 v9, v15, v15
v_add_f32 v12, v116, v10
v_add_f32 v13, v117, v10
v_fmac_f32 v8, v12, v12
v_fmac_f32 v9, v13, v13
v_add_f32 v14, v118, v10
v_add_f32 v15, v119, v10
v_fmac_f32 v8, v14, v14
v_fmac_f32 v9, v15, v15
v_add_f32 v12, v120, v10
v_add_f32 v13, v121, v10
v_fmac_f32 v8, v12, v12
v_fmac_f32 v9, v13, v13
v_add_f32 v14, v122, v10
v_add_f32 v15, v123, v10
v_fmac_f32 v8, v14, v14
v_fmac_f32 v9, v15, v15
v_add_f32 v12, v124, v10
v_add_f32 v13, v125, v10
v_fmac_f32 v8, v12, v12
v_fmac_f32 v9, v13, v13
v_add_f32 v14, v126, v10
v_add_f32 v15, v127, v10
v_fmac_f32 v8, v14, v14
v_fmac_f32 v9, v15, v15
v_add_f32 v12, v128, v10
v_add_f32 v13, v129, v10
v_fmac_f32 v8, v12, v12
v_fmac_f32 v9, v13, v13
v_add_f32 v14, v130, v10
v_add_f32 v15, v131, v10
v_fmac_f32 v8, v14, v14
v_fmac_f32 v9, v15, v15
v_add_f32 v12, v132, v10
v_add_f32 v13, v133, v10
v_fmac_f32 v8, v12, v12
v_fmac_f32 v9, v13, v13
v_add_f32 v14, v134, v10
v_add_f32 v15, v135, v10
v_fmac_f32 v8, v14, v14
v_fmac_f32 v9, v15, v15
v_add_f32 v8, v8, v9
s_nop 1
v_add_f32_dpp v8, v8, v8 quad_perm:[1,0,3,2] row_mask:0xf bank_mask:0xf
s_nop 1
v_add_f32_dpp v8, v8, v8 quad_perm:[2,3,0,1] row_mask:0xf bank_mask:0xf
s_nop 1
v_add_f32_dpp v8, v8, v8 row_half_mirror row_mask:0xf bank_mask:0xf
v_mul_f32 v8, 0x3acccccd, v8
v_cvt_pk_bf16_f32 v10, v10, v10
v_and_b32 v10, 0xffff0000, v10
v_cvt_pk_bf16_f32 v8, v8, v8
v_and_b32 v8, 0xffff0000, v8
v_add_f32 v8, 0x3727c5ac, v8
v_cvt_pk_bf16_f32 v8, v8, v8
v_and_b32 v8, 0xffff0000, v8
v_sqrt_f32 v8, v8
s_nop 0
v_cvt_pk_bf16_f32 v8, v8, v8
v_and_b32 v8, 0xffff0000, v8
v_rcp_f32 v9, v8
v_mov_b32 v12, v10
v_mul_f32 v13, 0xbfb8aa3b, v9
v_mul_f32 v14, v8, v8
v_mul_f32 v15, v8, v8
v_lshrrev_b32 v5, 3, v0
v_lshlrev_b32 v5, 4, v5
s_lshl_b32 s33, s25, 9
s_lshl_b32 s34, s24, 7
s_add_u32 s33, s33, s34
s_add_u32 s33, s33, 14680064
v_and_b32 v6, 7, v0
v_cmp_eq_u32 vcc, 0, v6
s_nop 0
s_and_saveexec_b64 s[34:35], vcc
buffer_store_dwordx4 v[12:15], v5, s[20:23], s33 offen sc1
s_mov_b64 exec, s[34:35]
v_mov_b32 v8, v9
v_mul_f32 v10, v10, v9
v_mov_b32 v11, v10
s_mov_b32 s8, s6
s_mov_b32 s9, s7
s_mov_b32 s10, 1966080
s_mov_b32 s11, 0x20000
s_lshl_b32 s38, s24, 12
s_add_u32 s38, s38, 40960
s_lshl_b32 s62, s24, 6
s_add_u32 s62, s62, s25
s_add_u32 s62, s62, 384
v_lshrrev_b32 v244, 3, v0
v_and_b32 v245, 2, v244
v_and_b32 v240, 7, v0
v_xor_b32 v240, v240, v245
v_mul_u32_u24 v244, 1280, v244
v_lshl_add_u32 v240, v240, 4, v244
v_xor_b32 v241, 64, v240
v_lshrrev_b32 v246, 4, v0
v_lshrrev_b32 v244, 2, v0
v_and_b32 v244, 3, v244
v_lshl_add_u32 v245, v246, 3, v244
v_lshl_add_u32 v245, v245, 7, s38
v_lshrrev_b32 v244, 1, v244
v_and_b32 v246, 1, v246
v_lshl_add_u32 v244, v246, 1, v244
v_lshl_add_u32 v245, v244, 5, v245
v_and_b32 v244, 3, v0
v_lshl_add_u32 v242, v244, 3, v245
v_lshlrev_b32 v243, 4, v0
v_fma_f32 v56, v56, v8, v10
v_fma_f32 v57, v57, v8, v10
v_fma_f32 v58, v58, v8, v10
v_fma_f32 v59, v59, v8, v10
v_cvt_pk_bf16_f32 v16, v56, v57
v_fma_f32 v60, v60, v8, v10
v_fma_f32 v61, v61, v8, v10
v_cvt_pk_bf16_f32 v17, v58, v59
v_fma_f32 v62, v62, v8, v10
v_fma_f32 v63, v63, v8, v10
v_cvt_pk_bf16_f32 v18, v60, v61
v_fma_f32 v64, v64, v8, v10
v_fma_f32 v65, v65, v8, v10
v_cvt_pk_bf16_f32 v19, v62, v63
ds_write_b128 v2, v[16:19] offset:0
v_fma_f32 v66, v66, v8, v10
v_fma_f32 v67, v67, v8, v10
v_cvt_pk_bf16_f32 v20, v64, v65
v_fma_f32 v68, v68, v8, v10
v_fma_f32 v69, v69, v8, v10
v_cvt_pk_bf16_f32 v21, v66, v67
v_fma_f32 v70, v70, v8, v10
v_fma_f32 v71, v71, v8, v10
v_cvt_pk_bf16_f32 v22, v68, v69
v_fma_f32 v72, v72, v8, v10
v_fma_f32 v73, v73, v8, v10
v_cvt_pk_bf16_f32 v23, v70, v71
ds_write_b128 v3, v[20:23] offset:0
v_fma_f32 v74, v74, v8, v10
v_fma_f32 v75, v75, v8, v10
v_cvt_pk_bf16_f32 v24, v72, v73
v_fma_f32 v76, v76, v8, v10
v_fma_f32 v77, v77, v8, v10
v_cvt_pk_bf16_f32 v25, v74, v75
v_fma_f32 v78, v78, v8, v10
v_fma_f32 v79, v79, v8, v10
v_cvt_pk_bf16_f32 v26, v76, v77
v_fma_f32 v80, v80, v8, v10
v_fma_f32 v81, v81, v8, v10
v_cvt_pk_bf16_f32 v27, v78, v79
ds_write_b128 v2, v[24:27] offset:256
v_fma_f32 v82, v82, v8, v10
v_fma_f32 v83, v83, v8, v10
v_cvt_pk_bf16_f32 v28, v80, v81
v_fma_f32 v84, v84, v8, v10
v_fma_f32 v85, v85, v8, v10
v_cvt_pk_bf16_f32 v29, v82, v83
v_fma_f32 v86, v86, v8, v10
v_fma_f32 v87, v87, v8, v10
v_cvt_pk_bf16_f32 v30, v84, v85
v_fma_f32 v88, v88, v8, v10
v_fma_f32 v89, v89, v8, v10
v_cvt_pk_bf16_f32 v31, v86, v87
ds_write_b128 v3, v[28:31] offset:256
v_fma_f32 v90, v90, v8, v10
v_fma_f32 v91, v91, v8, v10
v_cvt_pk_bf16_f32 v32, v88, v89
v_fma_f32 v92, v92, v8, v10
v_fma_f32 v93, v93, v8, v10
v_cvt_pk_bf16_f32 v33, v90, v91
v_fma_f32 v94, v94, v8, v10
v_fma_f32 v95, v95, v8, v10
v_cvt_pk_bf16_f32 v34, v92, v93
v_fma_f32 v96, v96, v8, v10
v_fma_f32 v97, v97, v8, v10
v_cvt_pk_bf16_f32 v35, v94, v95
ds_write_b128 v2, v[32:35] offset:512
v_fma_f32 v98, v98, v8, v10
v_fma_f32 v99, v99, v8, v10
v_cvt_pk_bf16_f32 v36, v96, v97
v_fma_f32 v100, v100, v8, v10
v_fma_f32 v101, v101, v8, v10
v_cvt_pk_bf16_f32 v37, v98, v99
v_fma_f32 v102, v102, v8, v10
v_fma_f32 v103, v103, v8, v10
v_cvt_pk_bf16_f32 v38, v100, v101
v_fma_f32 v104, v104, v8, v10
v_fma_f32 v105, v105, v8, v10
v_cvt_pk_bf16_f32 v39, v102, v103
ds_write_b128 v3, v[36:39] offset:512
v_fma_f32 v106, v106, v8, v10
v_fma_f32 v107, v107, v8, v10
v_cvt_pk_bf16_f32 v40, v104, v105
v_fma_f32 v108, v108, v8, v10
v_fma_f32 v109, v109, v8, v10
v_cvt_pk_bf16_f32 v41, v106, v107
v_fma_f32 v110, v110, v8, v10
v_fma_f32 v111, v111, v8, v10
v_cvt_pk_bf16_f32 v42, v108, v109
v_fma_f32 v112, v112, v8, v10
v_fma_f32 v113, v113, v8, v10
v_cvt_pk_bf16_f32 v43, v110, v111
ds_write_b128 v2, v[40:43] offset:768
v_fma_f32 v114, v114, v8, v10
v_fma_f32 v115, v115, v8, v10
v_cvt_pk_bf16_f32 v44, v112, v113
v_fma_f32 v116, v116, v8, v10
v_fma_f32 v117, v117, v8, v10
v_cvt_pk_bf16_f32 v45, v114, v115
v_fma_f32 v118, v118, v8, v10
v_fma_f32 v119, v119, v8, v10
v_cvt_pk_bf16_f32 v46, v116, v117
v_fma_f32 v120, v120, v8, v10
v_fma_f32 v121, v121, v8, v10
v_cvt_pk_bf16_f32 v47, v118, v119
ds_write_b128 v3, v[44:47] offset:768
v_fma_f32 v122, v122, v8, v10
v_fma_f32 v123, v123, v8, v10
v_cvt_pk_bf16_f32 v48, v120, v121
v_fma_f32 v124, v124, v8, v10
v_fma_f32 v125, v125, v8, v10
v_cvt_pk_bf16_f32 v49, v122, v123
v_fma_f32 v126, v126, v8, v10
v_fma_f32 v127, v127, v8, v10
v_cvt_pk_bf16_f32 v50, v124, v125
v_fma_f32 v128, v128, v8, v10
v_fma_f32 v129, v129, v8, v10
v_cvt_pk_bf16_f32 v51, v126, v127
ds_write_b128 v2, v[48:51] offset:1024
v_fma_f32 v130, v130, v8, v10
v_fma_f32 v131, v131, v8, v10
v_cvt_pk_bf16_f32 v52, v128, v129
v_fma_f32 v132, v132, v8, v10
v_fma_f32 v133, v133, v8, v10
v_cvt_pk_bf16_f32 v53, v130, v131
v_fma_f32 v134, v134, v8, v10
v_fma_f32 v135, v135, v8, v10
v_cvt_pk_bf16_f32 v54, v132, v133
v_cvt_pk_bf16_f32 v55, v134, v135
ds_write_b128 v3, v[52:55] offset:1024
v_lshrrev_b32 v4, 4, v0
v_lshrrev_b32 v5, 2, v0
v_and_b32 v5, 3, v5
v_and_b32 v6, 3, v0
v_lshl_add_u32 v12, v6, 3, v5
v_mul_u32_u24 v12, 1280, v12
v_and_b32 v13, 1, v4
v_lshl_add_u32 v12, v13, 3, v12
v_lshl_add_u32 v13, v6, 2, v5
v_lshrrev_b32 v14, 1, v4
s_lshl_b32 s33, s24, 2
v_add_u32 v14, s33, v14
v_xor_b32 v13, v13, v14
v_lshl_add_u32 v12, v13, 4, v12
v_xor_b32 v13, 32, v12
s_and_b32 s33, s25, 3
v_xor_b32 v14, s33, v6
v_lshlrev_b32 v14, 4, v14
v_lshl_add_u32 v14, v5, 6, v14
v_lshl_add_u32 v14, v4, 14, v14
s_lshl_b32 s26, s25, 8
s_lshl_b32 s33, s24, 17
s_add_u32 s26, s26, s33
s_add_u32 s26, s26, 8388608
s_waitcnt lgkmcnt(0)
s_barrier
s_cmp_ge_u32 s62, 480
s_cbranch_scc1 L_lw1
s_mul_i32 s60, s62, 6554
s_lshr_b32 s60, s60, 16
s_mul_i32 s61, s60, 10
s_sub_u32 s61, s62, s61
s_mul_i32 s37, s60, 40960
s_lshl_b32 s33, s61, 7
s_add_u32 s37, s37, s33
s_add_u32 m0, s38, 0
s_nop 0
buffer_load_dwordx4 v240, s[8:11], s37 offen nt lds
s_add_u32 s37, s37, 10240
s_add_u32 m0, s38, 1024
s_nop 0
buffer_load_dwordx4 v241, s[8:11], s37 offen nt lds
s_add_u32 s37, s37, 10240
s_add_u32 m0, s38, 2048
s_nop 0
buffer_load_dwordx4 v240, s[8:11], s37 offen nt lds
s_add_u32 s37, s37, 10240
s_add_u32 m0, s38, 3072
s_nop 0
buffer_load_dwordx4 v241, s[8:11], s37 offen nt lds
s_add_u32 s37, s37, 10240
L_lw1:
ds_read_b64_tr_b16 v[16:17], v12 offset:0
ds_read_b64_tr_b16 v[18:19], v12 offset:5120
ds_read_b64_tr_b16 v[20:21], v13 offset:0
ds_read_b64_tr_b16 v[22:23], v13 offset:5120
ds_read_b64_tr_b16 v[24:25], v12 offset:256
ds_read_b64_tr_b16 v[26:27], v12 offset:5376
ds_read_b64_tr_b16 v[28:29], v13 offset:256
ds_read_b64_tr_b16 v[30:31], v13 offset:5376
ds_read_b64_tr_b16 v[32:33], v12 offset:512
ds_read_b64_tr_b16 v[34:35], v12 offset:5632
ds_read_b64_tr_b16 v[36:37], v13 offset:512
ds_read_b64_tr_b16 v[38:39], v13 offset:5632
s_waitcnt lgkmcnt(4)
ds_read_b64_tr_b16 v[40:41], v12 offset:768
ds_read_b64_tr_b16 v[42:43], v12 offset:5888
ds_read_b64_tr_b16 v[44:45], v13 offset:768
ds_read_b64_tr_b16 v[46:47], v13 offset:5888
ds_read_b64_tr_b16 v[48:49], v12 offset:1024
ds_read_b64_tr_b16 v[50:51], v12 offset:6144
ds_read_b64_tr_b16 v[52:53], v13 offset:1024
ds_read_b64_tr_b16 v[54:55], v13 offset:6144
s_add_u32 s33, s26, 0
buffer_store_dwordx4 v[16:19], v14, s[20:23], s33 offen sc1
s_add_u32 s33, s26, 65536
buffer_store_dwordx4 v[20:23], v14, s[20:23], s33 offen sc1
s_add_u32 s33, s26, 524288
buffer_store_dwordx4 v[24:27], v14, s[20:23], s33 offen sc1
s_add_u32 s33, s26, 589824
buffer_store_dwordx4 v[28:31], v14, s[20:23], s33 offen sc1
s_waitcnt lgkmcnt(10)
s_add_u32 s33, s26, 1048576
buffer_store_dwordx4 v[32:35], v14, s[20:23], s33 offen sc1
s_waitcnt lgkmcnt(8)
s_add_u32 s33, s26, 1114112
buffer_store_dwordx4 v[36:39], v14, s[20:23], s33 offen sc1
s_waitcnt lgkmcnt(6)
s_add_u32 s33, s26, 1572864
buffer_store_dwordx4 v[40:43], v14, s[20:23], s33 offen sc1
s_waitcnt lgkmcnt(4)
s_add_u32 s33, s26, 1638400
buffer_store_dwordx4 v[44:47], v14, s[20:23], s33 offen sc1
s_waitcnt lgkmcnt(2)
s_add_u32 s33, s26, 2097152
buffer_store_dwordx4 v[48:51], v14, s[20:23], s33 offen sc1
s_waitcnt lgkmcnt(0)
s_add_u32 s33, s26, 2162688
buffer_store_dwordx4 v[52:55], v14, s[20:23], s33 offen sc1
s_waitcnt vmcnt(10)
s_cmp_ge_u32 s62, 480
s_cbranch_scc1 L_lw2
v_xor_b32 v244, 0, v242
ds_read_b64_tr_b16 v[60:61], v244 offset:0
ds_read_b64_tr_b16 v[62:63], v244 offset:512
v_xor_b32 v244, 32, v242
ds_read_b64_tr_b16 v[64:65], v244 offset:0
ds_read_b64_tr_b16 v[66:67], v244 offset:512
v_xor_b32 v244, 64, v242
ds_read_b64_tr_b16 v[68:69], v244 offset:0
ds_read_b64_tr_b16 v[70:71], v244 offset:512
v_xor_b32 v244, 96, v242
ds_read_b64_tr_b16 v[72:73], v244 offset:0
ds_read_b64_tr_b16 v[74:75], v244 offset:512
s_lshl_b32 s33, s61, 2
s_add_u32 s33, s33, 0
s_mul_i32 s39, s33, 205
s_lshr_b32 s39, s39, 10
s_mul_i32 s39, s39, 235
s_add_u32 s33, s33, s39
s_mul_i32 s39, s60, 5
s_add_u32 s33, s33, s39
s_lshl_b32 s33, s33, 10
s_add_u32 s33, s33, 6291456
s_waitcnt lgkmcnt(6)
buffer_store_dwordx4 v[60:63], v243, s[20:23], s33 offen sc1
s_lshl_b32 s33, s61, 2
s_add_u32 s33, s33, 1
s_mul_i32 s39, s33, 205
s_lshr_b32 s39, s39, 10
s_mul_i32 s39, s39, 235
s_add_u32 s33, s33, s39
s_mul_i32 s39, s60, 5
s_add_u32 s33, s33, s39
s_lshl_b32 s33, s33, 10
s_add_u32 s33, s33, 6291456
s_waitcnt lgkmcnt(4)
buffer_store_dwordx4 v[64:67], v243, s[20:23], s33 offen sc1
s_lshl_b32 s33, s61, 2
s_add_u32 s33, s33, 2
s_mul_i32 s39, s33, 205
s_lshr_b32 s39, s39, 10
s_mul_i32 s39, s39, 235
s_add_u32 s33, s33, s39
s_mul_i32 s39, s60, 5
s_add_u32 s33, s33, s39
s_lshl_b32 s33, s33, 10
s_add_u32 s33, s33, 6291456
s_waitcnt lgkmcnt(2)
buffer_store_dwordx4 v[68:71], v243, s[20:23], s33 offen sc1
s_lshl_b32 s33, s61, 2
s_add_u32 s33, s33, 3
s_mul_i32 s39, s33, 205
s_lshr_b32 s39, s39, 10
s_mul_i32 s39, s39, 235
s_add_u32 s33, s33, s39
s_mul_i32 s39, s60, 5
s_add_u32 s33, s33, s39
s_lshl_b32 s33, s33, 10
s_add_u32 s33, s33, 6291456
s_waitcnt lgkmcnt(0)
buffer_store_dwordx4 v[72:75], v243, s[20:23], s33 offen sc1
L_lw2:
s_waitcnt vmcnt(0)
s_barrier
s_cmp_lg_u32 s24, 0
s_cbranch_scc1 L_lnd_x
v_mov_b32 v6, 0
v_mov_b32 v7, 1
v_cmp_eq_u32 vcc, 0, v0
s_nop 0
s_and_saveexec_b64 s[34:35], vcc
buffer_atomic_add v7, v6, s[48:51], 0 offen offset:0 sc0 sc1
s_mov_b64 exec, s[34:35]
s_waitcnt vmcnt(0)
v_readfirstlane_b32 s33, v7
s_nop 0
s_cmp_lg_u32 s33, 95
s_cbranch_scc1 L_lnd_x
v_mov_b32 v7, 1
v_cmp_eq_u32 vcc, 0, v0
s_nop 0
s_and_saveexec_b64 s[34:35], vcc
buffer_store_dword v7, v6, s[48:51], 0 offen offset:128 sc1
s_mov_b64 exec, s[34:35]
L_lnd_x:
s_endpgm
L_pw:
s_load_dwordx2 s[4:5], s[0:1], 96
s_load_dwordx4 s[44:47], s[0:1], 112
s_sub_u32 s25, s2, 224
s_lshl_b32 s25, s25, 2
s_add_u32 s25, s25, s24
s_mul_i32 s25, s25, 3
s_lshl_b32 s38, s24, 14
s_setprio 3
v_lshrrev_b32 v244, 3, v0
v_and_b32 v245, 2, v244
v_and_b32 v240, 7, v0
v_xor_b32 v240, v240, v245
v_mul_u32_u24 v244, 1280, v244
v_lshl_add_u32 v240, v240, 4, v244
v_xor_b32 v241, 64, v240
v_lshrrev_b32 v246, 4, v0
v_lshrrev_b32 v244, 2, v0
v_and_b32 v244, 3, v244
v_lshl_add_u32 v245, v246, 3, v244
v_lshl_add_u32 v245, v245, 7, s38
v_lshrrev_b32 v244, 1, v244
v_and_b32 v246, 1, v246
v_lshl_add_u32 v244, v246, 1, v244
v_lshl_add_u32 v245, v244, 5, v245
v_and_b32 v244, 3, v0
v_lshl_add_u32 v242, v244, 3, v245
v_lshlrev_b32 v243, 4, v0
v_mov_b32 v22, 0
s_waitcnt lgkmcnt(0)
s_mov_b32 s8, s4
s_mov_b32 s9, s5
s_mov_b32 s10, 1966080
s_mov_b32 s11, 0x20000
s_mov_b32 s20, s46
s_mov_b32 s21, s47
s_mov_b32 s22, 33554432
s_mov_b32 s23, 0x20000
s_mov_b32 s48, s44
s_mov_b32 s49, s45
s_mov_b32 s50, 256
s_mov_b32 s51, 0x20000
s_cmp_ge_u32 s25, 480
s_cbranch_scc1 L_pw_none
s_mul_i32 s60, s25, 6554
s_lshr_b32 s60, s60, 16
s_mul_i32 s61, s60, 10
s_sub_u32 s61, s25, s61
s_mul_i32 s37, s60, 40960
s_lshl_b32 s33, s61, 7
s_add_u32 s37, s37, s33
s_add_u32 m0, s38, 0
s_nop 0
buffer_load_dwordx4 v240, s[8:11], s37 offen nt lds
s_add_u32 s37, s37, 10240
s_add_u32 m0, s38, 1024
s_nop 0
buffer_load_dwordx4 v241, s[8:11], s37 offen nt lds
s_add_u32 s37, s37, 10240
s_add_u32 m0, s38, 2048
s_nop 0
buffer_load_dwordx4 v240, s[8:11], s37 offen nt lds
s_add_u32 s37, s37, 10240
s_add_u32 m0, s38, 3072
s_nop 0
buffer_load_dwordx4 v241, s[8:11], s37 offen nt lds
s_add_u32 s37, s37, 10240
s_add_u32 s25, s25, 1
s_mul_i32 s62, s25, 6554
s_lshr_b32 s62, s62, 16
s_mul_i32 s63, s62, 10
s_sub_u32 s63, s25, s63
s_mul_i32 s37, s62, 40960
s_lshl_b32 s33, s63, 7
s_add_u32 s37, s37, s33
s_add_u32 m0, s38, 4096
s_nop 0
buffer_load_dwordx4 v240, s[8:11], s37 offen nt lds
s_add_u32 s37, s37, 10240
s_add_u32 m0, s38, 5120
s_nop 0
buffer_load_dwordx4 v241, s[8:11], s37 offen nt lds
s_add_u32 s37, s37, 10240
s_add_u32 m0, s38, 6144
s_nop 0
buffer_load_dwordx4 v240, s[8:11], s37 offen nt lds
s_add_u32 s37, s37, 10240
s_add_u32 m0, s38, 7168
s_nop 0
buffer_load_dwordx4 v241, s[8:11], s37 offen nt lds
s_add_u32 s37, s37, 10240
s_add_u32 s25, s25, 1
s_mul_i32 s64, s25, 6554
s_lshr_b32 s64, s64, 16
s_mul_i32 s65, s64, 10
s_sub_u32 s65, s25, s65
s_mul_i32 s37, s64, 40960
s_lshl_b32 s33, s65, 7
s_add_u32 s37, s37, s33
s_add_u32 m0, s38, 8192
s_nop 0
buffer_load_dwordx4 v240, s[8:11], s37 offen nt lds
s_add_u32 s37, s37, 10240
s_add_u32 m0, s38, 9216
s_nop 0
buffer_load_dwordx4 v241, s[8:11], s37 offen nt lds
s_add_u32 s37, s37, 10240
s_add_u32 m0, s38, 10240
s_nop 0
buffer_load_dwordx4 v240, s[8:11], s37 offen nt lds
s_add_u32 s37, s37, 10240
s_add_u32 m0, s38, 11264
s_nop 0
buffer_load_dwordx4 v241, s[8:11], s37 offen nt lds
s_add_u32 s37, s37, 10240
s_add_u32 s25, s25, 1
s_waitcnt vmcnt(8)
v_xor_b32 v244, 0, v242
ds_read_b64_tr_b16 v[16:17], v244 offset:0
ds_read_b64_tr_b16 v[18:19], v244 offset:512
v_xor_b32 v244, 32, v242
ds_read_b64_tr_b16 v[20:21], v244 offset:0
ds_read_b64_tr_b16 v[22:23], v244 offset:512
v_xor_b32 v244, 64, v242
ds_read_b64_tr_b16 v[24:25], v244 offset:0
ds_read_b64_tr_b16 v[26:27], v244 offset:512
v_xor_b32 v244, 96, v242
ds_read_b64_tr_b16 v[28:29], v244 offset:0
ds_read_b64_tr_b16 v[30:31], v244 offset:512
s_lshl_b32 s33, s61, 2
s_add_u32 s33, s33, 0
s_mul_i32 s39, s33, 205
s_lshr_b32 s39, s39, 10
s_mul_i32 s39, s39, 235
s_add_u32 s33, s33, s39
s_mul_i32 s39, s60, 5
s_add_u32 s33, s33, s39
s_lshl_b32 s33, s33, 10
s_add_u32 s33, s33, 6291456
s_waitcnt lgkmcnt(6)
buffer_store_dwordx4 v[16:19], v243, s[20:23], s33 offen sc1
s_lshl_b32 s33, s61, 2
s_add_u32 s33, s33, 1
s_mul_i32 s39, s33, 205
s_lshr_b32 s39, s39, 10
s_mul_i32 s39, s39, 235
s_add_u32 s33, s33, s39
s_mul_i32 s39, s60, 5
s_add_u32 s33, s33, s39
s_lshl_b32 s33, s33, 10
s_add_u32 s33, s33, 6291456
s_waitcnt lgkmcnt(4)
buffer_store_dwordx4 v[20:23], v243, s[20:23], s33 offen sc1
s_lshl_b32 s33, s61, 2
s_add_u32 s33, s33, 2
s_mul_i32 s39, s33, 205
s_lshr_b32 s39, s39, 10
s_mul_i32 s39, s39, 235
s_add_u32 s33, s33, s39
s_mul_i32 s39, s60, 5
s_add_u32 s33, s33, s39
s_lshl_b32 s33, s33, 10
s_add_u32 s33, s33, 6291456
s_waitcnt lgkmcnt(2)
buffer_store_dwordx4 v[24:27], v243, s[20:23], s33 offen sc1
s_lshl_b32 s33, s61, 2
s_add_u32 s33, s33, 3
s_mul_i32 s39, s33, 205
s_lshr_b32 s39, s39, 10
s_mul_i32 s39, s39, 235
s_add_u32 s33, s33, s39
s_mul_i32 s39, s60, 5
s_add_u32 s33, s33, s39
s_lshl_b32 s33, s33, 10
s_add_u32 s33, s33, 6291456
s_waitcnt lgkmcnt(0)
buffer_store_dwordx4 v[28:31], v243, s[20:23], s33 offen sc1
s_waitcnt vmcnt(8)
v_xor_b32 v244, 0, v242
ds_read_b64_tr_b16 v[32:33], v244 offset:4096
ds_read_b64_tr_b16 v[34:35], v244 offset:4608
v_xor_b32 v244, 32, v242
ds_read_b64_tr_b16 v[36:37], v244 offset:4096
ds_read_b64_tr_b16 v[38:39], v244 offset:4608
v_xor_b32 v244, 64, v242
ds_read_b64_tr_b16 v[40:41], v244 offset:4096
ds_read_b64_tr_b16 v[42:43], v244 offset:4608
v_xor_b32 v244, 96, v242
ds_read_b64_tr_b16 v[44:45], v244 offset:4096
ds_read_b64_tr_b16 v[46:47], v244 offset:4608
s_lshl_b32 s33, s63, 2
s_add_u32 s33, s33, 0
s_mul_i32 s39, s33, 205
s_lshr_b32 s39, s39, 10
s_mul_i32 s39, s39, 235
s_add_u32 s33, s33, s39
s_mul_i32 s39, s62, 5
s_add_u32 s33, s33, s39
s_lshl_b32 s33, s33, 10
s_add_u32 s33, s33, 6291456
s_waitcnt lgkmcnt(6)
buffer_store_dwordx4 v[32:35], v243, s[20:23], s33 offen sc1
s_lshl_b32 s33, s63, 2
s_add_u32 s33, s33, 1
s_mul_i32 s39, s33, 205
s_lshr_b32 s39, s39, 10
s_mul_i32 s39, s39, 235
s_add_u32 s33, s33, s39
s_mul_i32 s39, s62, 5
s_add_u32 s33, s33, s39
s_lshl_b32 s33, s33, 10
s_add_u32 s33, s33, 6291456
s_waitcnt lgkmcnt(4)
buffer_store_dwordx4 v[36:39], v243, s[20:23], s33 offen sc1
s_lshl_b32 s33, s63, 2
s_add_u32 s33, s33, 2
s_mul_i32 s39, s33, 205
s_lshr_b32 s39, s39, 10
s_mul_i32 s39, s39, 235
s_add_u32 s33, s33, s39
s_mul_i32 s39, s62, 5
s_add_u32 s33, s33, s39
s_lshl_b32 s33, s33, 10
s_add_u32 s33, s33, 6291456
s_waitcnt lgkmcnt(2)
buffer_store_dwordx4 v[40:43], v243, s[20:23], s33 offen sc1
s_lshl_b32 s33, s63, 2
s_add_u32 s33, s33, 3
s_mul_i32 s39, s33, 205
s_lshr_b32 s39, s39, 10
s_mul_i32 s39, s39, 235
s_add_u32 s33, s33, s39
s_mul_i32 s39, s62, 5
s_add_u32 s33, s33, s39
s_lshl_b32 s33, s33, 10
s_add_u32 s33, s33, 6291456
s_waitcnt lgkmcnt(0)
buffer_store_dwordx4 v[44:47], v243, s[20:23], s33 offen sc1
s_waitcnt vmcnt(8)
v_xor_b32 v244, 0, v242
ds_read_b64_tr_b16 v[48:49], v244 offset:8192
ds_read_b64_tr_b16 v[50:51], v244 offset:8704
v_xor_b32 v244, 32, v242
ds_read_b64_tr_b16 v[52:53], v244 offset:8192
ds_read_b64_tr_b16 v[54:55], v244 offset:8704
v_xor_b32 v244, 64, v242
ds_read_b64_tr_b16 v[56:57], v244 offset:8192
ds_read_b64_tr_b16 v[58:59], v244 offset:8704
v_xor_b32 v244, 96, v242
ds_read_b64_tr_b16 v[60:61], v244 offset:8192
ds_read_b64_tr_b16 v[62:63], v244 offset:8704
s_lshl_b32 s33, s65, 2
s_add_u32 s33, s33, 0
s_mul_i32 s39, s33, 205
s_lshr_b32 s39, s39, 10
s_mul_i32 s39, s39, 235
s_add_u32 s33, s33, s39
s_mul_i32 s39, s64, 5
s_add_u32 s33, s33, s39
s_lshl_b32 s33, s33, 10
s_add_u32 s33, s33, 6291456
s_waitcnt lgkmcnt(6)
buffer_store_dwordx4 v[48:51], v243, s[20:23], s33 offen sc1
s_lshl_b32 s33, s65, 2
s_add_u32 s33, s33, 1
s_mul_i32 s39, s33, 205
s_lshr_b32 s39, s39, 10
s_mul_i32 s39, s39, 235
s_add_u32 s33, s33, s39
s_mul_i32 s39, s64, 5
s_add_u32 s33, s33, s39
s_lshl_b32 s33, s33, 10
s_add_u32 s33, s33, 6291456
s_waitcnt lgkmcnt(4)
buffer_store_dwordx4 v[52:55], v243, s[20:23], s33 offen sc1
s_lshl_b32 s33, s65, 2
s_add_u32 s33, s33, 2
s_mul_i32 s39, s33, 205
s_lshr_b32 s39, s39, 10
s_mul_i32 s39, s39, 235
s_add_u32 s33, s33, s39
s_mul_i32 s39, s64, 5
s_add_u32 s33, s33, s39
s_lshl_b32 s33, s33, 10
s_add_u32 s33, s33, 6291456
s_waitcnt lgkmcnt(2)
buffer_store_dwordx4 v[56:59], v243, s[20:23], s33 offen sc1
s_lshl_b32 s33, s65, 2
s_add_u32 s33, s33, 3
s_mul_i32 s39, s33, 205
s_lshr_b32 s39, s39, 10
s_mul_i32 s39, s39, 235
s_add_u32 s33, s33, s39
s_mul_i32 s39, s64, 5
s_add_u32 s33, s33, s39
s_lshl_b32 s33, s33, 10
s_add_u32 s33, s33, 6291456
s_waitcnt lgkmcnt(0)
buffer_store_dwordx4 v[60:63], v243, s[20:23], s33 offen sc1
L_pw_none:
s_waitcnt vmcnt(0)
s_barrier
s_cmp_lg_u32 s24, 0
s_cbranch_scc1 L_pwd_x
v_mov_b32 v6, 0
v_mov_b32 v7, 1
v_cmp_eq_u32 vcc, 0, v0
s_nop 0
s_and_saveexec_b64 s[34:35], vcc
buffer_atomic_add v7, v6, s[48:51], 0 offen offset:0 sc0 sc1
s_mov_b64 exec, s[34:35]
s_waitcnt vmcnt(0)
v_readfirstlane_b32 s33, v7
s_nop 0
s_cmp_lg_u32 s33, 95
s_cbranch_scc1 L_pwd_x
v_mov_b32 v7, 1
v_cmp_eq_u32 vcc, 0, v0
s_nop 0
s_and_saveexec_b64 s[34:35], vcc
buffer_store_dword v7, v6, s[48:51], 0 offen offset:128 sc1
s_mov_b64 exec, s[34:35]
L_pwd_x:
s_endpgm
L_kc:
s_load_dwordx8 s[80:87], s[0:1], 8
s_load_dwordx8 s[88:95], s[0:1], 40
s_load_dwordx2 s[4:5], s[0:1], 96
s_load_dwordx4 s[44:47], s[0:1], 112
s_sub_u32 s25, s2, 0
s_lshl_b32 s29, s25, 2
s_add_u32 s29, s29, s24
s_mul_i32 s26, s29, 384
v_lshlrev_b32 v49, 1, v0
v_lshlrev_b32 v50, 2, v0
s_lshl_b32 s27, s29, 1
v_mov_b32 v51, s27
s_waitcnt lgkmcnt(0)
s_mov_b32 s12, s92
s_mov_b32 s13, s93
s_mov_b32 s14, 1280
s_mov_b32 s15, 0x20000
buffer_load_ushort v3, v51, s[12:15], 0 offen
s_mov_b32 s56, s80
s_mov_b32 s57, s81
s_mov_b32 s58, 245760
s_mov_b32 s59, 0x20000
buffer_load_dword v8, v50, s[56:59], s26 offen nt
s_mov_b32 s60, s82
s_mov_b32 s61, s83
s_mov_b32 s62, 245760
s_mov_b32 s63, 0x20000
buffer_load_dword v9, v50, s[60:63], s26 offen nt
s_mov_b32 s64, s84
s_mov_b32 s65, s85
s_mov_b32 s66, 245760
s_mov_b32 s67, 0x20000
buffer_load_dword v10, v50, s[64:67], s26 offen nt
s_mov_b32 s68, s86
s_mov_b32 s69, s87
s_mov_b32 s70, 245760
s_mov_b32 s71, 0x20000
buffer_load_dword v11, v50, s[68:71], s26 offen nt
s_mov_b32 s72, s88
s_mov_b32 s73, s89
s_mov_b32 s74, 245760
s_mov_b32 s75, 0x20000
buffer_load_dword v12, v50, s[72:75], s26 offen nt
s_mov_b32 s76, s90
s_mov_b32 s77, s91
s_mov_b32 s78, 245760
s_mov_b32 s79, 0x20000
buffer_load_dword v13, v50, s[76:79], s26 offen nt
buffer_load_ushort v20, v49, s[56:59], s26 offen offset:256 nt
buffer_load_ushort v21, v49, s[60:63], s26 offen offset:256 nt
buffer_load_ushort v22, v49, s[64:67], s26 offen offset:256 nt
buffer_load_ushort v23, v49, s[68:71], s26 offen offset:256 nt
buffer_load_ushort v24, v49, s[72:75], s26 offen offset:256 nt
buffer_load_ushort v25, v49, s[76:79], s26 offen offset:256 nt
s_mov_b32 s16, s94
s_mov_b32 s17, s95
s_mov_b32 s18, 1280
s_mov_b32 s19, 0x20000
buffer_load_ushort v5, v51, s[16:19], 0 offen
s_mov_b32 s20, s46
s_mov_b32 s21, s47
s_mov_b32 s22, 33554432
s_mov_b32 s23, 0x20000
s_mov_b32 s48, s44
s_mov_b32 s49, s45
s_mov_b32 s50, 256
s_mov_b32 s51, 0x20000
s_mov_b32 s8, s4
s_mov_b32 s9, s5
s_mov_b32 s10, 1966080
s_mov_b32 s11, 0x20000
s_lshl_b32 s28, s24, 14
s_mov_b32 m0, s28
v_and_b32 v4, 15, v0
v_lshrrev_b32 v2, 4, v0
v_mul_u32_u24 v42, 272, v4
v_lshl_add_u32 v42, v2, 4, v42
v_add_u32 v42, s28, v42
v_mov_b64 v[52:53], 0
v_mov_b64 v[54:55], 0
v_mov_b64 v[56:57], 0
v_mov_b64 v[58:59], 0
v_mov_b64 v[60:61], 0
v_mov_b64 v[62:63], 0
v_mov_b32 v64, 0x3c00
v_lshlrev_b32 v1, 4, v0
v_cmp_gt_u32 vcc, 2, v2
v_lshlrev_b32 v6, 4, v4
v_lshl_add_u32 v7, v2, 2, v6
v_add_u32 v7, 1, v7
v_cvt_f32_u32 v132, v7
v_lshl_add_u32 v7, v2, 9, v6
v_add_u32 v7, 1032, v7
v_cndmask_b32 v7, v6, v7, vcc
v_cvt_f32_u32 v135, v7
v_lshl_add_u32 v7, v2, 3, v6
v_add_u32 v7, 258, v7
v_lshl_add_u32 v6, v2, 8, v6
v_add_u32 v6, 4, v6
v_cndmask_b32 v7, v6, v7, vcc
v_cvt_f32_u32 v133, v7
v_mov_b32 v6, 4.0
v_cndmask_b32 v134, v6, 2.0, vcc
v_lshlrev_b32 v6, 3, v2
v_lshl_add_u32 v6, v4, 5, v6
v_add_u32 v46, s28, v6
v_lshlrev_b32 v7, 3, v2
v_lshl_add_u32 v7, v4, 4, v7
v_add_u32 v7, 520, v7
v_lshlrev_b32 v6, 7, v2
v_lshl_add_u32 v6, v4, 3, v6
v_add_u32 v6, 672, v6
v_cndmask_b32 v7, v6, v7, vcc
v_add_u32 v47, s28, v7
v_lshlrev_b32 v6, 7, v2
v_lshl_add_u32 v6, v4, 2, v6
v_add_u32 v7, 1392, v6
v_add_u32 v6, 4096, v6
v_cndmask_b32 v7, v6, v7, vcc
v_add_u32 v48, s28, v7
s_add_u32 s36, s28, 6
s_add_u32 s33, s36, 4294933248
v_mov_b32 v120, s33
v_lshlrev_b32 v121, 3, v0
v_sub_u32 v121, 511, v121
v_cvt_f32_i32 v122, v121
v_add_f32 v6, 0x00000000, v122
v_add_f32 v7, 0xbf800000, v122
v_cvt_pk_bf16_f32 v6, v6, v7
v_mad_u32_u16 v140, v6, 2, v120
v_mad_u32_u16 v141, v6, 2, v120 op_sel:[1,0,0,0]
v_add_f32 v6, 0xc0000000, v122
v_add_f32 v7, 0xc0400000, v122
v_cvt_pk_bf16_f32 v6, v6, v7
v_mad_u32_u16 v142, v6, 2, v120
v_mad_u32_u16 v143, v6, 2, v120 op_sel:[1,0,0,0]
v_add_f32 v6, 0xc0800000, v122
v_add_f32 v7, 0xc0a00000, v122
v_cvt_pk_bf16_f32 v6, v6, v7
v_mad_u32_u16 v144, v6, 2, v120
v_mad_u32_u16 v145, v6, 2, v120 op_sel:[1,0,0,0]
v_add_f32 v6, 0xc0c00000, v122
v_add_f32 v7, 0xc0e00000, v122
v_cvt_pk_bf16_f32 v6, v6, v7
v_mad_u32_u16 v146, v6, 2, v120
v_mad_u32_u16 v147, v6, 2, v120 op_sel:[1,0,0,0]
v_add_f32 v6, 0xc1000000, v122
v_add_f32 v7, 0xc1100000, v122
v_cvt_pk_bf16_f32 v6, v6, v7
v_mad_u32_u16 v148, v6, 2, v120
v_subrev_u32 v6, 0, v121
v_cmp_gt_i32 vcc, 128, v6
v_lshl_add_u32 v6, v6, 1, s36
s_nop 0
v_cndmask_b32 v140, v140, v6, vcc
v_subrev_u32 v6, 1, v121
v_cmp_gt_i32 vcc, 128, v6
v_lshl_add_u32 v6, v6, 1, s36
s_nop 0
v_cndmask_b32 v141, v141, v6, vcc
v_subrev_u32 v6, 2, v121
v_cmp_gt_i32 vcc, 128, v6
v_lshl_add_u32 v6, v6, 1, s36
s_nop 0
v_cndmask_b32 v142, v142, v6, vcc
v_subrev_u32 v6, 3, v121
v_cmp_gt_i32 vcc, 128, v6
v_lshl_add_u32 v6, v6, 1, s36
s_nop 0
v_cndmask_b32 v143, v143, v6, vcc
v_subrev_u32 v6, 4, v121
v_cmp_gt_i32 vcc, 128, v6
v_lshl_add_u32 v6, v6, 1, s36
s_nop 0
v_cndmask_b32 v144, v144, v6, vcc
v_subrev_u32 v6, 5, v121
v_cmp_gt_i32 vcc, 128, v6
v_lshl_add_u32 v6, v6, 1, s36
s_nop 0
v_cndmask_b32 v145, v145, v6, vcc
v_subrev_u32 v6, 6, v121
v_cmp_gt_i32 vcc, 128, v6
v_lshl_add_u32 v6, v6, 1, s36
s_nop 0
v_cndmask_b32 v146, v146, v6, vcc
v_subrev_u32 v6, 7, v121
v_cmp_gt_i32 vcc, 128, v6
v_lshl_add_u32 v6, v6, 1, s36
s_nop 0
v_cndmask_b32 v147, v147, v6, vcc
v_subrev_u32 v6, 8, v121
v_cmp_gt_i32 vcc, 128, v6
v_lshl_add_u32 v6, v6, 1, s36
s_nop 0
v_cndmask_b32 v148, v148, v6, vcc
v_lshlrev_b32 v120, 3, v2
v_mov_b32 v6, 14336
v_lshlrev_b32 v6, v4, v6
v_lshrrev_b32 v6, v120, v6
v_bfe_u32 v7, v6, 0, 1
v_bfe_u32 v121, v6, 1, 1
v_lshl_or_b32 v7, v121, 16, v7
v_mul_u32_u24 v232, 0x3f80, v7
v_bfe_u32 v7, v6, 2, 1
v_bfe_u32 v121, v6, 3, 1
v_lshl_or_b32 v7, v121, 16, v7
v_mul_u32_u24 v233, 0x3f80, v7
v_bfe_u32 v7, v6, 4, 1
v_bfe_u32 v121, v6, 5, 1
v_lshl_or_b32 v7, v121, 16, v7
v_mul_u32_u24 v234, 0x3f80, v7
v_bfe_u32 v7, v6, 6, 1
v_bfe_u32 v121, v6, 7, 1
v_lshl_or_b32 v7, v121, 16, v7
v_mul_u32_u24 v235, 0x3f80, v7
v_mov_b32 v6, 1984
v_lshlrev_b32 v6, v4, v6
v_lshrrev_b32 v6, v120, v6
v_bfe_u32 v7, v6, 0, 1
v_bfe_u32 v121, v6, 1, 1
v_lshl_or_b32 v7, v121, 16, v7
v_mul_u32_u24 v236, 0x3f80, v7
v_bfe_u32 v7, v6, 2, 1
v_bfe_u32 v121, v6, 3, 1
v_lshl_or_b32 v7, v121, 16, v7
v_mul_u32_u24 v237, 0x3f80, v7
v_bfe_u32 v7, v6, 4, 1
v_bfe_u32 v121, v6, 5, 1
v_lshl_or_b32 v7, v121, 16, v7
v_mul_u32_u24 v238, 0x3f80, v7
v_bfe_u32 v7, v6, 6, 1
v_bfe_u32 v121, v6, 7, 1
v_lshl_or_b32 v7, v121, 16, v7
v_mul_u32_u24 v239, 0x3f80, v7
v_mov_b32 v6, 4064
v_lshlrev_b32 v6, v4, v6
v_lshrrev_b32 v6, v120, v6
v_bfe_u32 v7, v6, 0, 1
v_bfe_u32 v121, v6, 1, 1
v_lshl_or_b32 v7, v121, 16, v7
v_mul_u32_u24 v240, 0x3f80, v7
v_bfe_u32 v7, v6, 2, 1
v_bfe_u32 v121, v6, 3, 1
v_lshl_or_b32 v7, v121, 16, v7
v_mul_u32_u24 v241, 0x3f80, v7
v_bfe_u32 v7, v6, 4, 1
v_bfe_u32 v121, v6, 5, 1
v_lshl_or_b32 v7, v121, 16, v7
v_mul_u32_u24 v242, 0x3f80, v7
v_bfe_u32 v7, v6, 6, 1
v_bfe_u32 v121, v6, 7, 1
v_lshl_or_b32 v7, v121, 16, v7
v_mul_u32_u24 v243, 0x3f80, v7
v_mov_b32 v6, 8176
v_lshlrev_b32 v6, v4, v6
v_lshrrev_b32 v6, v120, v6
v_bfe_u32 v7, v6, 0, 1
v_bfe_u32 v121, v6, 1, 1
v_lshl_or_b32 v7, v121, 16, v7
v_mul_u32_u24 v244, 0x3f80, v7
v_bfe_u32 v7, v6, 2, 1
v_bfe_u32 v121, v6, 3, 1
v_lshl_or_b32 v7, v121, 16, v7
v_mul_u32_u24 v245, 0x3f80, v7
v_bfe_u32 v7, v6, 4, 1
v_bfe_u32 v121, v6, 5, 1
v_lshl_or_b32 v7, v121, 16, v7
v_mul_u32_u24 v246, 0x3f80, v7
v_bfe_u32 v7, v6, 6, 1
v_bfe_u32 v121, v6, 7, 1
v_lshl_or_b32 v7, v121, 16, v7
v_mul_u32_u24 v247, 0x3f80, v7
v_mov_b32 v6, 12288
v_lshlrev_b32 v6, v4, v6
v_lshrrev_b32 v6, v120, v6
v_bfe_u32 v7, v6, 0, 1
v_bfe_u32 v121, v6, 1, 1
v_lshl_or_b32 v7, v121, 16, v7
v_mul_u32_u24 v248, 0xffff, v7
v_bfe_u32 v7, v6, 2, 1
v_bfe_u32 v121, v6, 3, 1
v_lshl_or_b32 v7, v121, 16, v7
v_mul_u32_u24 v249, 0xffff, v7
v_bfe_u32 v7, v6, 4, 1
v_bfe_u32 v121, v6, 5, 1
v_lshl_or_b32 v7, v121, 16, v7
v_mul_u32_u24 v250, 0xffff, v7
v_bfe_u32 v7, v6, 6, 1
v_bfe_u32 v121, v6, 7, 1
v_lshl_or_b32 v7, v121, 16, v7
v_mul_u32_u24 v251, 0xffff, v7
s_lshl_b32 s33, s25, 14
s_lshl_b32 s37, s24, 12
s_add_u32 s33, s33, s37
s_add_u32 s38, s33, 8388608
s_add_u32 s39, s33, 11534336
v_mov_b32 v252, 0
s_waitcnt vmcnt(0)
v_lshlrev_b32 v3, 16, v3
v_mul_f32 v3, 0x3fb8aa3b, v3
v_exp_f32 v3, v3
s_nop 0
v_cvt_pk_bf16_f32 v3, v3, v3
v_and_b32 v3, 0xffff0000, v3
v_and_b32 v14, 0xffff0000, v8
v_lshlrev_b32 v8, 16, v8
v_lshlrev_b32 v20, 16, v20
v_and_b32 v15, 0xffff0000, v9
v_lshlrev_b32 v9, 16, v9
v_lshlrev_b32 v21, 16, v21
v_and_b32 v16, 0xffff0000, v10
v_lshlrev_b32 v10, 16, v10
v_lshlrev_b32 v22, 16, v22
v_and_b32 v17, 0xffff0000, v11
v_lshlrev_b32 v11, 16, v11
v_lshlrev_b32 v23, 16, v23
v_and_b32 v18, 0xffff0000, v12
v_lshlrev_b32 v12, 16, v12
v_lshlrev_b32 v24, 16, v24
v_and_b32 v19, 0xffff0000, v13
v_lshlrev_b32 v13, 16, v13
v_lshlrev_b32 v25, 16, v25
v_mul_f32 v8, v3, v8
v_mul_f32 v9, v3, v9
v_mul_f32 v6, v12, v10
v_mul_f32 v7, v13, v10
v_mul_f32 v8, 0x3fb8aa3b, v8
v_mul_f32 v9, 0.15915494, v9
v_fma_f32 v10, -v13, v11, v6
v_fma_f32 v11, v12, v11, v7
v_mul_f32 v14, v3, v14
v_mul_f32 v15, v3, v15
v_mul_f32 v6, v18, v16
v_mul_f32 v7, v19, v16
v_mul_f32 v14, 0x3fb8aa3b, v14
v_mul_f32 v15, 0.15915494, v15
v_fma_f32 v16, -v19, v17, v6
v_fma_f32 v17, v18, v17, v7
v_mul_f32 v20, v3, v20
v_mul_f32 v21, v3, v21
v_mul_f32 v6, v24, v22
v_mul_f32 v7, v25, v22
v_mul_f32 v20, 0x3fb8aa3b, v20
v_mul_f32 v21, 0.15915494, v21
v_fma_f32 v22, -v25, v23, v6
v_fma_f32 v23, v24, v23, v7
v_max3_f32 v136, v8, v14, v20
v_max3_f32 v137, |v10|, |v11|, |v16|
v_max3_f32 v6, |v17|, |v22|, |v23|
v_max_f32 v137, v137, v6
v_max_f32_dpp v136, v136, v136 row_ror:8 row_mask:0xf bank_mask:0xf
s_nop 0
v_max_f32_dpp v137, v137, v137 row_ror:8 row_mask:0xf bank_mask:0xf
v_max_f32_dpp v136, v136, v136 row_ror:4 row_mask:0xf bank_mask:0xf
s_nop 0
v_max_f32_dpp v137, v137, v137 row_ror:4 row_mask:0xf bank_mask:0xf
v_max_f32_dpp v136, v136, v136 row_ror:2 row_mask:0xf bank_mask:0xf
s_nop 0
v_max_f32_dpp v137, v137, v137 row_ror:2 row_mask:0xf bank_mask:0xf
v_max_f32_dpp v136, v136, v136 row_ror:1 row_mask:0xf bank_mask:0xf
s_nop 0
v_max_f32_dpp v137, v137, v137 row_ror:1 row_mask:0xf bank_mask:0xf
v_mov_b32 v6, v136
v_mov_b32 v7, v137
s_nop 0
v_permlane16_swap_b32 v136, v6
v_permlane16_swap_b32 v137, v7
v_max_f32 v136, v136, v6
v_max_f32 v137, v137, v7
v_mov_b32 v6, v136
v_mov_b32 v7, v137
s_nop 0
v_permlane32_swap_b32 v136, v6
v_permlane32_swap_b32 v137, v7
v_max_f32 v136, v136, v6
v_max_f32 v137, v137, v7
v_frexp_exp_i32_f32 v137, v137
v_sub_u32 v7, 0, v137
v_cvt_f32_i32 v137, v137
v_sub_f32 v8, v8, v136
v_ldexp_f32 v10, v10, v7
v_ldexp_f32 v11, v11, v7
v_cvt_pk_f16_f32 v10, v10, -v11
v_sub_f32 v14, v14, v136
v_ldexp_f32 v16, v16, v7
v_ldexp_f32 v17, v17, v7
v_cvt_pk_f16_f32 v16, v16, -v17
v_sub_f32 v20, v20, v136
v_ldexp_f32 v22, v22, v7
v_ldexp_f32 v23, v23, v7
v_cvt_pk_f16_f32 v22, v22, -v23
v_mul_f32 v120, 0x3f800000, v8
v_mul_f32 v122, 0x41800000, v8
v_mul_f32 v124, 0x43800000, v8
v_mul_f32 v121, 0x3f800000, v9
v_mul_f32 v123, 0x41800000, v9
v_mul_f32 v125, 0x43800000, v9
v_exp_f32 v120, v120
v_exp_f32 v122, v122
v_exp_f32 v124, v124
v_fract_f32 v121, v121
v_fract_f32 v123, v123
v_fract_f32 v125, v125
v_cos_f32 v108, v121
v_cos_f32 v110, v123
v_cos_f32 v112, v125
v_sin_f32 v109, v121
v_sin_f32 v111, v123
v_sin_f32 v113, v125
v_mul_f32 v108, v108, v120
v_mul_f32 v109, v109, v120
v_mul_f32 v110, v110, v122
v_mul_f32 v111, v111, v122
v_mul_f32 v112, v112, v124
v_mul_f32 v113, v113, v124
v_cvt_pk_f16_f32 v65, v108, v109
v_cvt_pk_f16_f32 v96, v110, v111
v_cvt_pk_f16_f32 v100, v112, v113
v_mul_f32 v120, v109, v109
v_add_f32 v121, v108, v108
v_mul_f32 v122, v111, v111
v_add_f32 v123, v110, v110
v_mul_f32 v124, v113, v113
v_add_f32 v125, v112, v112
v_fma_f32 v108, v108, v108, -v120
v_mul_f32 v109, v109, v121
v_fma_f32 v110, v110, v110, -v122
v_mul_f32 v111, v111, v123
v_fma_f32 v112, v112, v112, -v124
v_mul_f32 v113, v113, v125
v_cvt_pk_f16_f32 v66, v108, v109
v_cvt_pk_f16_f32 v97, v110, v111
v_cvt_pk_f16_f32 v101, v112, v113
v_mul_f32 v120, v109, v109
v_add_f32 v121, v108, v108
v_mul_f32 v122, v111, v111
v_add_f32 v123, v110, v110
v_mul_f32 v124, v113, v113
v_add_f32 v125, v112, v112
v_fma_f32 v108, v108, v108, -v120
v_mul_f32 v109, v109, v121
v_fma_f32 v110, v110, v110, -v122
v_mul_f32 v111, v111, v123
v_fma_f32 v112, v112, v112, -v124
v_mul_f32 v113, v113, v125
v_cvt_pk_f16_f32 v68, v108, v109
v_cvt_pk_f16_f32 v98, v110, v111
v_cvt_pk_f16_f32 v103, v112, v113
v_mul_f32 v120, v109, v109
v_add_f32 v121, v108, v108
v_mul_f32 v122, v111, v111
v_add_f32 v123, v110, v110
v_fma_f32 v108, v108, v108, -v120
v_mul_f32 v109, v109, v121
v_fma_f32 v110, v110, v110, -v122
v_mul_f32 v111, v111, v123
v_cvt_pk_f16_f32 v72, v108, v109
v_cvt_pk_f16_f32 v99, v110, v111
ds_write_addtid_b32 v65 offset:0
v_pk_mul_f16 v81, v10, v96 op_sel:[0,0] op_sel_hi:[1,0]
ds_write_addtid_b32 v10 offset:11152
v_pk_fma_f16 v81, v10, v96, v81 op_sel:[1,1,0] op_sel_hi:[0,1,1] neg_hi:[1,0,0]
ds_write_addtid_b32 v66 offset:272
v_pk_mul_f16 v67, v65, v66 op_sel:[0,0] op_sel_hi:[1,0]
v_pk_mul_f16 v82, v10, v97 op_sel:[0,0] op_sel_hi:[1,0]
ds_write_addtid_b32 v81 offset:11424
v_pk_fma_f16 v67, v65, v66, v67 op_sel:[1,1,0] op_sel_hi:[0,1,1] neg_lo:[1,0,0]
v_pk_fma_f16 v82, v10, v97, v82 op_sel:[1,1,0] op_sel_hi:[0,1,1] neg_hi:[1,0,0]
ds_write_addtid_b32 v67 offset:544
v_pk_mul_f16 v83, v81, v97 op_sel:[0,0] op_sel_hi:[1,0]
v_pk_mul_f16 v102, v101, v100 op_sel:[0,0] op_sel_hi:[1,0]
ds_write_addtid_b32 v82 offset:11696
v_pk_fma_f16 v83, v81, v97, v83 op_sel:[1,1,0] op_sel_hi:[0,1,1] neg_hi:[1,0,0]
v_pk_fma_f16 v102, v101, v100, v102 op_sel:[1,1,0] op_sel_hi:[0,1,1] neg_lo:[1,0,0]
ds_write_addtid_b32 v68 offset:816
v_pk_mul_f16 v69, v65, v68 op_sel:[0,0] op_sel_hi:[1,0]
v_pk_mul_f16 v84, v10, v98 op_sel:[0,0] op_sel_hi:[1,0]
ds_write_addtid_b32 v83 offset:11968
v_pk_fma_f16 v69, v65, v68, v69 op_sel:[1,1,0] op_sel_hi:[0,1,1] neg_lo:[1,0,0]
v_pk_fma_f16 v84, v10, v98, v84 op_sel:[1,1,0] op_sel_hi:[0,1,1] neg_hi:[1,0,0]
ds_write_addtid_b32 v69 offset:1088
v_pk_mul_f16 v70, v66, v68 op_sel:[0,0] op_sel_hi:[1,0]
v_pk_mul_f16 v85, v81, v98 op_sel:[0,0] op_sel_hi:[1,0]
v_pk_mul_f16 v104, v103, v100 op_sel:[0,0] op_sel_hi:[1,0]
ds_write_addtid_b32 v84 offset:12240
v_pk_fma_f16 v70, v66, v68, v70 op_sel:[1,1,0] op_sel_hi:[0,1,1] neg_lo:[1,0,0]
v_pk_fma_f16 v85, v81, v98, v85 op_sel:[1,1,0] op_sel_hi:[0,1,1] neg_hi:[1,0,0]
v_pk_fma_f16 v104, v103, v100, v104 op_sel:[1,1,0] op_sel_hi:[0,1,1] neg_lo:[1,0,0]
ds_write_addtid_b32 v70 offset:1360
v_pk_mul_f16 v71, v67, v68 op_sel:[0,0] op_sel_hi:[1,0]
v_pk_mul_f16 v86, v82, v98 op_sel:[0,0] op_sel_hi:[1,0]
ds_write_addtid_b32 v85 offset:12512
v_pk_fma_f16 v71, v67, v68, v71 op_sel:[1,1,0] op_sel_hi:[0,1,1] neg_lo:[1,0,0]
v_pk_fma_f16 v86, v82, v98, v86 op_sel:[1,1,0] op_sel_hi:[0,1,1] neg_hi:[1,0,0]
ds_write_addtid_b32 v71 offset:1632
v_pk_mul_f16 v87, v83, v98 op_sel:[0,0] op_sel_hi:[1,0]
v_pk_mul_f16 v105, v103, v101 op_sel:[0,0] op_sel_hi:[1,0]
ds_write_addtid_b32 v86 offset:12784
v_pk_fma_f16 v87, v83, v98, v87 op_sel:[1,1,0] op_sel_hi:[0,1,1] neg_hi:[1,0,0]
v_pk_fma_f16 v105, v103, v101, v105 op_sel:[1,1,0] op_sel_hi:[0,1,1] neg_lo:[1,0,0]
ds_write_addtid_b32 v72 offset:1904
v_pk_mul_f16 v73, v65, v72 op_sel:[0,0] op_sel_hi:[1,0]
v_pk_mul_f16 v88, v10, v99 op_sel:[0,0] op_sel_hi:[1,0]
ds_write_addtid_b32 v87 offset:13056
v_pk_fma_f16 v73, v65, v72, v73 op_sel:[1,1,0] op_sel_hi:[0,1,1] neg_lo:[1,0,0]
v_pk_fma_f16 v88, v10, v99, v88 op_sel:[1,1,0] op_sel_hi:[0,1,1] neg_hi:[1,0,0]
ds_write_addtid_b32 v73 offset:2176
v_pk_mul_f16 v74, v66, v72 op_sel:[0,0] op_sel_hi:[1,0]
v_pk_mul_f16 v89, v81, v99 op_sel:[0,0] op_sel_hi:[1,0]
ds_write_addtid_b32 v88 offset:13328
v_pk_fma_f16 v74, v66, v72, v74 op_sel:[1,1,0] op_sel_hi:[0,1,1] neg_lo:[1,0,0]
v_pk_fma_f16 v89, v81, v99, v89 op_sel:[1,1,0] op_sel_hi:[0,1,1] neg_hi:[1,0,0]
ds_write_addtid_b32 v74 offset:2448
v_pk_mul_f16 v75, v67, v72 op_sel:[0,0] op_sel_hi:[1,0]
v_pk_mul_f16 v90, v82, v99 op_sel:[0,0] op_sel_hi:[1,0]
ds_write_addtid_b32 v89 offset:13600
v_pk_fma_f16 v75, v67, v72, v75 op_sel:[1,1,0] op_sel_hi:[0,1,1] neg_lo:[1,0,0]
v_pk_fma_f16 v90, v82, v99, v90 op_sel:[1,1,0] op_sel_hi:[0,1,1] neg_hi:[1,0,0]
ds_write_addtid_b32 v75 offset:2720
v_pk_mul_f16 v76, v68, v72 op_sel:[0,0] op_sel_hi:[1,0]
v_pk_mul_f16 v91, v83, v99 op_sel:[0,0] op_sel_hi:[1,0]
ds_write_addtid_b32 v90 offset:13872
v_pk_fma_f16 v76, v68, v72, v76 op_sel:[1,1,0] op_sel_hi:[0,1,1] neg_lo:[1,0,0]
v_pk_fma_f16 v91, v83, v99, v91 op_sel:[1,1,0] op_sel_hi:[0,1,1] neg_hi:[1,0,0]
ds_write_addtid_b32 v76 offset:2992
v_pk_mul_f16 v77, v69, v72 op_sel:[0,0] op_sel_hi:[1,0]
v_pk_mul_f16 v92, v84, v99 op_sel:[0,0] op_sel_hi:[1,0]
ds_write_addtid_b32 v91 offset:14144
v_pk_fma_f16 v77, v69, v72, v77 op_sel:[1,1,0] op_sel_hi:[0,1,1] neg_lo:[1,0,0]
v_pk_fma_f16 v92, v84, v99, v92 op_sel:[1,1,0] op_sel_hi:[0,1,1] neg_hi:[1,0,0]
ds_write_addtid_b32 v77 offset:3264
v_pk_mul_f16 v78, v70, v72 op_sel:[0,0] op_sel_hi:[1,0]
v_pk_mul_f16 v93, v85, v99 op_sel:[0,0] op_sel_hi:[1,0]
ds_write_addtid_b32 v92 offset:14416
v_pk_fma_f16 v78, v70, v72, v78 op_sel:[1,1,0] op_sel_hi:[0,1,1] neg_lo:[1,0,0]
v_pk_fma_f16 v93, v85, v99, v93 op_sel:[1,1,0] op_sel_hi:[0,1,1] neg_hi:[1,0,0]
ds_write_addtid_b32 v78 offset:3536
v_pk_mul_f16 v79, v71, v72 op_sel:[0,0] op_sel_hi:[1,0]
v_pk_mul_f16 v94, v86, v99 op_sel:[0,0] op_sel_hi:[1,0]
ds_write_addtid_b32 v93 offset:14688
v_pk_fma_f16 v79, v71, v72, v79 op_sel:[1,1,0] op_sel_hi:[0,1,1] neg_lo:[1,0,0]
v_pk_fma_f16 v94, v86, v99, v94 op_sel:[1,1,0] op_sel_hi:[0,1,1] neg_hi:[1,0,0]
ds_write_addtid_b32 v79 offset:3808
v_pk_mul_f16 v95, v87, v99 op_sel:[0,0] op_sel_hi:[1,0]
v_pk_mul_f16 v106, v103, v102 op_sel:[0,0] op_sel_hi:[1,0]
ds_write_addtid_b32 v94 offset:14960
v_pk_fma_f16 v95, v87, v99, v95 op_sel:[1,1,0] op_sel_hi:[0,1,1] neg_hi:[1,0,0]
v_pk_fma_f16 v106, v103, v102, v106 op_sel:[1,1,0] op_sel_hi:[0,1,1] neg_lo:[1,0,0]
v_pk_mul_f16 v128, v66, v100 op_sel:[0,0] op_sel_hi:[1,0]
v_pk_mul_f16 v129, v72, v103 op_sel:[0,0] op_sel_hi:[1,0]
ds_write_addtid_b32 v96 offset:4080
v_pk_fma_f16 v128, v66, v100, v128 op_sel:[1,1,0] op_sel_hi:[0,1,1] neg_lo:[1,0,0]
v_pk_fma_f16 v129, v72, v103, v129 op_sel:[1,1,0] op_sel_hi:[0,1,1] neg_lo:[1,0,0]
ds_write_addtid_b32 v95 offset:15232
v_pk_mul_f16 v130, v68, v100 op_sel:[0,0] op_sel_hi:[1,0]
v_pk_mul_f16 v131, v96, v103 op_sel:[0,0] op_sel_hi:[1,0]
ds_write_addtid_b32 v128 offset:4352
v_pk_fma_f16 v130, v68, v100, v130 op_sel:[1,1,0] op_sel_hi:[0,1,1] neg_lo:[1,0,0]
v_pk_fma_f16 v131, v96, v103, v131 op_sel:[1,1,0] op_sel_hi:[0,1,1] neg_lo:[1,0,0]
ds_write_addtid_b32 v129 offset:8704
v_pk_mul_f16 v128, v70, v100 op_sel:[0,0] op_sel_hi:[1,0]
v_pk_mul_f16 v129, v72, v104 op_sel:[0,0] op_sel_hi:[1,0]
ds_write_addtid_b32 v130 offset:4624
v_pk_fma_f16 v128, v70, v100, v128 op_sel:[1,1,0] op_sel_hi:[0,1,1] neg_lo:[1,0,0]
v_pk_fma_f16 v129, v72, v104, v129 op_sel:[1,1,0] op_sel_hi:[0,1,1] neg_lo:[1,0,0]
ds_write_addtid_b32 v131 offset:8976
v_pk_mul_f16 v130, v72, v100 op_sel:[0,0] op_sel_hi:[1,0]
v_pk_mul_f16 v131, v96, v104 op_sel:[0,0] op_sel_hi:[1,0]
ds_write_addtid_b32 v128 offset:4896
v_pk_fma_f16 v130, v72, v100, v130 op_sel:[1,1,0] op_sel_hi:[0,1,1] neg_lo:[1,0,0]
v_pk_fma_f16 v131, v96, v104, v131 op_sel:[1,1,0] op_sel_hi:[0,1,1] neg_lo:[1,0,0]
ds_write_addtid_b32 v129 offset:9248
v_pk_mul_f16 v128, v74, v100 op_sel:[0,0] op_sel_hi:[1,0]
v_pk_mul_f16 v129, v72, v105 op_sel:[0,0] op_sel_hi:[1,0]
ds_write_addtid_b32 v130 offset:5168
v_pk_fma_f16 v128, v74, v100, v128 op_sel:[1,1,0] op_sel_hi:[0,1,1] neg_lo:[1,0,0]
v_pk_fma_f16 v129, v72, v105, v129 op_sel:[1,1,0] op_sel_hi:[0,1,1] neg_lo:[1,0,0]
ds_write_addtid_b32 v131 offset:9520
v_pk_mul_f16 v130, v76, v100 op_sel:[0,0] op_sel_hi:[1,0]
v_pk_mul_f16 v131, v96, v105 op_sel:[0,0] op_sel_hi:[1,0]
ds_write_addtid_b32 v128 offset:5440
v_pk_fma_f16 v130, v76, v100, v130 op_sel:[1,1,0] op_sel_hi:[0,1,1] neg_lo:[1,0,0]
v_pk_fma_f16 v131, v96, v105, v131 op_sel:[1,1,0] op_sel_hi:[0,1,1] neg_lo:[1,0,0]
ds_write_addtid_b32 v129 offset:9792
v_pk_mul_f16 v128, v78, v100 op_sel:[0,0] op_sel_hi:[1,0]
v_pk_mul_f16 v129, v72, v106 op_sel:[0,0] op_sel_hi:[1,0]
ds_write_addtid_b32 v130 offset:5712
v_pk_fma_f16 v128, v78, v100, v128 op_sel:[1,1,0] op_sel_hi:[0,1,1] neg_lo:[1,0,0]
v_pk_fma_f16 v129, v72, v106, v129 op_sel:[1,1,0] op_sel_hi:[0,1,1] neg_lo:[1,0,0]
ds_write_addtid_b32 v131 offset:10064
v_pk_mul_f16 v130, v96, v100 op_sel:[0,0] op_sel_hi:[1,0]
v_pk_mul_f16 v131, v96, v106 op_sel:[0,0] op_sel_hi:[1,0]
ds_write_addtid_b32 v128 offset:5984
v_pk_fma_f16 v130, v96, v100, v130 op_sel:[1,1,0] op_sel_hi:[0,1,1] neg_lo:[1,0,0]
v_pk_fma_f16 v131, v96, v106, v131 op_sel:[1,1,0] op_sel_hi:[0,1,1] neg_lo:[1,0,0]
ds_write_addtid_b32 v129 offset:10336
v_pk_mul_f16 v128, v68, v101 op_sel:[0,0] op_sel_hi:[1,0]
ds_write_addtid_b32 v130 offset:6256
v_pk_fma_f16 v128, v68, v101, v128 op_sel:[1,1,0] op_sel_hi:[0,1,1] neg_lo:[1,0,0]
ds_write_addtid_b32 v131 offset:10608
v_pk_mul_f16 v130, v72, v101 op_sel:[0,0] op_sel_hi:[1,0]
ds_write_addtid_b32 v128 offset:6528
v_pk_fma_f16 v130, v72, v101, v130 op_sel:[1,1,0] op_sel_hi:[0,1,1] neg_lo:[1,0,0]
ds_write_addtid_b32 v64 offset:10880
v_pk_mul_f16 v128, v76, v101 op_sel:[0,0] op_sel_hi:[1,0]
ds_write_addtid_b32 v130 offset:6800
v_pk_fma_f16 v128, v76, v101, v128 op_sel:[1,1,0] op_sel_hi:[0,1,1] neg_lo:[1,0,0]
v_pk_mul_f16 v130, v96, v101 op_sel:[0,0] op_sel_hi:[1,0]
ds_write_addtid_b32 v128 offset:7072
v_pk_fma_f16 v130, v96, v101, v130 op_sel:[1,1,0] op_sel_hi:[0,1,1] neg_lo:[1,0,0]
v_pk_mul_f16 v128, v68, v102 op_sel:[0,0] op_sel_hi:[1,0]
ds_write_addtid_b32 v130 offset:7344
v_pk_fma_f16 v128, v68, v102, v128 op_sel:[1,1,0] op_sel_hi:[0,1,1] neg_lo:[1,0,0]
v_pk_mul_f16 v130, v72, v102 op_sel:[0,0] op_sel_hi:[1,0]
ds_write_addtid_b32 v128 offset:7616
v_pk_fma_f16 v130, v72, v102, v130 op_sel:[1,1,0] op_sel_hi:[0,1,1] neg_lo:[1,0,0]
v_pk_mul_f16 v128, v76, v102 op_sel:[0,0] op_sel_hi:[1,0]
ds_write_addtid_b32 v130 offset:7888
v_pk_fma_f16 v128, v76, v102, v128 op_sel:[1,1,0] op_sel_hi:[0,1,1] neg_lo:[1,0,0]
v_pk_mul_f16 v130, v96, v102 op_sel:[0,0] op_sel_hi:[1,0]
ds_write_addtid_b32 v128 offset:8160
v_pk_fma_f16 v130, v96, v102, v130 op_sel:[1,1,0] op_sel_hi:[0,1,1] neg_lo:[1,0,0]
ds_write_addtid_b32 v130 offset:8432
s_waitcnt lgkmcnt(6)
ds_read_b128 v[164:167], v42 offset:11152
ds_read_b128 v[152:155], v42 offset:0
ds_read_b128 v[156:159], v42 offset:4352
ds_read_b128 v[160:163], v42 offset:8704
ds_read_b128 v[180:183], v42 offset:11216
ds_read_b128 v[168:171], v42 offset:64
ds_read_b128 v[172:175], v42 offset:4416
ds_read_b128 v[176:179], v42 offset:8768
s_waitcnt lgkmcnt(6)
ds_read_b128 v[196:199], v42 offset:11280
ds_read_b128 v[184:187], v42 offset:128
ds_read_b128 v[188:191], v42 offset:4480
ds_read_b128 v[192:195], v42 offset:8832
ds_read_b128 v[212:215], v42 offset:11344
ds_read_b128 v[200:203], v42 offset:192
ds_read_b128 v[204:207], v42 offset:4544
ds_read_b128 v[208:211], v42 offset:8896
v_mul_f32 v120, 0x3f800000, v14
v_mul_f32 v122, 0x41800000, v14
v_mul_f32 v124, 0x43800000, v14
v_mul_f32 v121, 0x3f800000, v15
v_mul_f32 v123, 0x41800000, v15
v_mul_f32 v125, 0x43800000, v15
v_exp_f32 v120, v120
v_exp_f32 v122, v122
v_exp_f32 v124, v124
v_fract_f32 v121, v121
v_fract_f32 v123, v123
v_fract_f32 v125, v125
v_cos_f32 v108, v121
v_cos_f32 v110, v123
v_cos_f32 v112, v125
v_sin_f32 v109, v121
v_sin_f32 v111, v123
v_sin_f32 v113, v125
v_mul_f32 v108, v108, v120
v_mul_f32 v109, v109, v120
v_mul_f32 v110, v110, v122
v_mul_f32 v111, v111, v122
v_mul_f32 v112, v112, v124
v_mul_f32 v113, v113, v124
s_waitcnt lgkmcnt(0)
s_setprio 3
v_mfma_f32_16x16x32_f16 v[52:55], v[152:155], v[164:167], v[52:55]
v_mfma_f32_16x16x32_f16 v[56:59], v[156:159], v[164:167], v[56:59]
v_mfma_f32_16x16x32_f16 v[60:63], v[160:163], v[164:167], v[60:63]
v_mfma_f32_16x16x32_f16 v[52:55], v[168:171], v[180:183], v[52:55]
v_mfma_f32_16x16x32_f16 v[56:59], v[172:175], v[180:183], v[56:59]
v_mfma_f32_16x16x32_f16 v[60:63], v[176:179], v[180:183], v[60:63]
v_mfma_f32_16x16x32_f16 v[52:55], v[184:187], v[196:199], v[52:55]
v_mfma_f32_16x16x32_f16 v[56:59], v[188:191], v[196:199], v[56:59]
v_mfma_f32_16x16x32_f16 v[60:63], v[192:195], v[196:199], v[60:63]
v_mfma_f32_16x16x32_f16 v[52:55], v[200:203], v[212:215], v[52:55]
v_mfma_f32_16x16x32_f16 v[56:59], v[204:207], v[212:215], v[56:59]
v_mfma_f32_16x16x32_f16 v[60:63], v[208:211], v[212:215], v[60:63]
s_setprio 0
v_cvt_pk_f16_f32 v65, v108, v109
v_cvt_pk_f16_f32 v96, v110, v111
v_cvt_pk_f16_f32 v100, v112, v113
v_mul_f32 v120, v109, v109
v_add_f32 v121, v108, v108
v_mul_f32 v122, v111, v111
v_add_f32 v123, v110, v110
v_mul_f32 v124, v113, v113
v_add_f32 v125, v112, v112
v_fma_f32 v108, v108, v108, -v120
v_mul_f32 v109, v109, v121
v_fma_f32 v110, v110, v110, -v122
v_mul_f32 v111, v111, v123
v_fma_f32 v112, v112, v112, -v124
v_mul_f32 v113, v113, v125
v_cvt_pk_f16_f32 v66, v108, v109
v_cvt_pk_f16_f32 v97, v110, v111
v_cvt_pk_f16_f32 v101, v112, v113
v_mul_f32 v120, v109, v109
v_add_f32 v121, v108, v108
v_mul_f32 v122, v111, v111
v_add_f32 v123, v110, v110
v_mul_f32 v124, v113, v113
v_add_f32 v125, v112, v112
v_fma_f32 v108, v108, v108, -v120
v_mul_f32 v109, v109, v121
v_fma_f32 v110, v110, v110, -v122
v_mul_f32 v111, v111, v123
v_fma_f32 v112, v112, v112, -v124
v_mul_f32 v113, v113, v125
v_cvt_pk_f16_f32 v68, v108, v109
v_cvt_pk_f16_f32 v98, v110, v111
v_cvt_pk_f16_f32 v103, v112, v113
v_mul_f32 v120, v109, v109
v_add_f32 v121, v108, v108
v_mul_f32 v122, v111, v111
v_add_f32 v123, v110, v110
v_fma_f32 v108, v108, v108, -v120
v_mul_f32 v109, v109, v121
v_fma_f32 v110, v110, v110, -v122
v_mul_f32 v111, v111, v123
v_cvt_pk_f16_f32 v72, v108, v109
v_cvt_pk_f16_f32 v99, v110, v111
ds_write_addtid_b32 v65 offset:0
v_pk_mul_f16 v81, v16, v96 op_sel:[0,0] op_sel_hi:[1,0]
ds_write_addtid_b32 v16 offset:11152
v_pk_fma_f16 v81, v16, v96, v81 op_sel:[1,1,0] op_sel_hi:[0,1,1] neg_hi:[1,0,0]
ds_write_addtid_b32 v66 offset:272
v_pk_mul_f16 v67, v65, v66 op_sel:[0,0] op_sel_hi:[1,0]
v_pk_mul_f16 v82, v16, v97 op_sel:[0,0] op_sel_hi:[1,0]
ds_write_addtid_b32 v81 offset:11424
v_pk_fma_f16 v67, v65, v66, v67 op_sel:[1,1,0] op_sel_hi:[0,1,1] neg_lo:[1,0,0]
v_pk_fma_f16 v82, v16, v97, v82 op_sel:[1,1,0] op_sel_hi:[0,1,1] neg_hi:[1,0,0]
ds_write_addtid_b32 v67 offset:544
v_pk_mul_f16 v83, v81, v97 op_sel:[0,0] op_sel_hi:[1,0]
v_pk_mul_f16 v102, v101, v100 op_sel:[0,0] op_sel_hi:[1,0]
ds_write_addtid_b32 v82 offset:11696
v_pk_fma_f16 v83, v81, v97, v83 op_sel:[1,1,0] op_sel_hi:[0,1,1] neg_hi:[1,0,0]
v_pk_fma_f16 v102, v101, v100, v102 op_sel:[1,1,0] op_sel_hi:[0,1,1] neg_lo:[1,0,0]
ds_write_addtid_b32 v68 offset:816
v_pk_mul_f16 v69, v65, v68 op_sel:[0,0] op_sel_hi:[1,0]
v_pk_mul_f16 v84, v16, v98 op_sel:[0,0] op_sel_hi:[1,0]
ds_write_addtid_b32 v83 offset:11968
v_pk_fma_f16 v69, v65, v68, v69 op_sel:[1,1,0] op_sel_hi:[0,1,1] neg_lo:[1,0,0]
v_pk_fma_f16 v84, v16, v98, v84 op_sel:[1,1,0] op_sel_hi:[0,1,1] neg_hi:[1,0,0]
ds_write_addtid_b32 v69 offset:1088
v_pk_mul_f16 v70, v66, v68 op_sel:[0,0] op_sel_hi:[1,0]
v_pk_mul_f16 v85, v81, v98 op_sel:[0,0] op_sel_hi:[1,0]
v_pk_mul_f16 v104, v103, v100 op_sel:[0,0] op_sel_hi:[1,0]
ds_write_addtid_b32 v84 offset:12240
v_pk_fma_f16 v70, v66, v68, v70 op_sel:[1,1,0] op_sel_hi:[0,1,1] neg_lo:[1,0,0]
v_pk_fma_f16 v85, v81, v98, v85 op_sel:[1,1,0] op_sel_hi:[0,1,1] neg_hi:[1,0,0]
v_pk_fma_f16 v104, v103, v100, v104 op_sel:[1,1,0] op_sel_hi:[0,1,1] neg_lo:[1,0,0]
ds_write_addtid_b32 v70 offset:1360
v_pk_mul_f16 v71, v67, v68 op_sel:[0,0] op_sel_hi:[1,0]
v_pk_mul_f16 v86, v82, v98 op_sel:[0,0] op_sel_hi:[1,0]
ds_write_addtid_b32 v85 offset:12512
v_pk_fma_f16 v71, v67, v68, v71 op_sel:[1,1,0] op_sel_hi:[0,1,1] neg_lo:[1,0,0]
v_pk_fma_f16 v86, v82, v98, v86 op_sel:[1,1,0] op_sel_hi:[0,1,1] neg_hi:[1,0,0]
ds_write_addtid_b32 v71 offset:1632
v_pk_mul_f16 v87, v83, v98 op_sel:[0,0] op_sel_hi:[1,0]
v_pk_mul_f16 v105, v103, v101 op_sel:[0,0] op_sel_hi:[1,0]
ds_write_addtid_b32 v86 offset:12784
v_pk_fma_f16 v87, v83, v98, v87 op_sel:[1,1,0] op_sel_hi:[0,1,1] neg_hi:[1,0,0]
v_pk_fma_f16 v105, v103, v101, v105 op_sel:[1,1,0] op_sel_hi:[0,1,1] neg_lo:[1,0,0]
ds_write_addtid_b32 v72 offset:1904
v_pk_mul_f16 v73, v65, v72 op_sel:[0,0] op_sel_hi:[1,0]
v_pk_mul_f16 v88, v16, v99 op_sel:[0,0] op_sel_hi:[1,0]
ds_write_addtid_b32 v87 offset:13056
v_pk_fma_f16 v73, v65, v72, v73 op_sel:[1,1,0] op_sel_hi:[0,1,1] neg_lo:[1,0,0]
v_pk_fma_f16 v88, v16, v99, v88 op_sel:[1,1,0] op_sel_hi:[0,1,1] neg_hi:[1,0,0]
ds_write_addtid_b32 v73 offset:2176
v_pk_mul_f16 v74, v66, v72 op_sel:[0,0] op_sel_hi:[1,0]
v_pk_mul_f16 v89, v81, v99 op_sel:[0,0] op_sel_hi:[1,0]
ds_write_addtid_b32 v88 offset:13328
v_pk_fma_f16 v74, v66, v72, v74 op_sel:[1,1,0] op_sel_hi:[0,1,1] neg_lo:[1,0,0]
v_pk_fma_f16 v89, v81, v99, v89 op_sel:[1,1,0] op_sel_hi:[0,1,1] neg_hi:[1,0,0]
ds_write_addtid_b32 v74 offset:2448
v_pk_mul_f16 v75, v67, v72 op_sel:[0,0] op_sel_hi:[1,0]
v_pk_mul_f16 v90, v82, v99 op_sel:[0,0] op_sel_hi:[1,0]
ds_write_addtid_b32 v89 offset:13600
v_pk_fma_f16 v75, v67, v72, v75 op_sel:[1,1,0] op_sel_hi:[0,1,1] neg_lo:[1,0,0]
v_pk_fma_f16 v90, v82, v99, v90 op_sel:[1,1,0] op_sel_hi:[0,1,1] neg_hi:[1,0,0]
ds_write_addtid_b32 v75 offset:2720
v_pk_mul_f16 v76, v68, v72 op_sel:[0,0] op_sel_hi:[1,0]
v_pk_mul_f16 v91, v83, v99 op_sel:[0,0] op_sel_hi:[1,0]
ds_write_addtid_b32 v90 offset:13872
v_pk_fma_f16 v76, v68, v72, v76 op_sel:[1,1,0] op_sel_hi:[0,1,1] neg_lo:[1,0,0]
v_pk_fma_f16 v91, v83, v99, v91 op_sel:[1,1,0] op_sel_hi:[0,1,1] neg_hi:[1,0,0]
ds_write_addtid_b32 v76 offset:2992
v_pk_mul_f16 v77, v69, v72 op_sel:[0,0] op_sel_hi:[1,0]
v_pk_mul_f16 v92, v84, v99 op_sel:[0,0] op_sel_hi:[1,0]
ds_write_addtid_b32 v91 offset:14144
v_pk_fma_f16 v77, v69, v72, v77 op_sel:[1,1,0] op_sel_hi:[0,1,1] neg_lo:[1,0,0]
v_pk_fma_f16 v92, v84, v99, v92 op_sel:[1,1,0] op_sel_hi:[0,1,1] neg_hi:[1,0,0]
ds_write_addtid_b32 v77 offset:3264
v_pk_mul_f16 v78, v70, v72 op_sel:[0,0] op_sel_hi:[1,0]
v_pk_mul_f16 v93, v85, v99 op_sel:[0,0] op_sel_hi:[1,0]
ds_write_addtid_b32 v92 offset:14416
v_pk_fma_f16 v78, v70, v72, v78 op_sel:[1,1,0] op_sel_hi:[0,1,1] neg_lo:[1,0,0]
v_pk_fma_f16 v93, v85, v99, v93 op_sel:[1,1,0] op_sel_hi:[0,1,1] neg_hi:[1,0,0]
ds_write_addtid_b32 v78 offset:3536
v_pk_mul_f16 v79, v71, v72 op_sel:[0,0] op_sel_hi:[1,0]
v_pk_mul_f16 v94, v86, v99 op_sel:[0,0] op_sel_hi:[1,0]
ds_write_addtid_b32 v93 offset:14688
v_pk_fma_f16 v79, v71, v72, v79 op_sel:[1,1,0] op_sel_hi:[0,1,1] neg_lo:[1,0,0]
v_pk_fma_f16 v94, v86, v99, v94 op_sel:[1,1,0] op_sel_hi:[0,1,1] neg_hi:[1,0,0]
ds_write_addtid_b32 v79 offset:3808
v_pk_mul_f16 v95, v87, v99 op_sel:[0,0] op_sel_hi:[1,0]
v_pk_mul_f16 v106, v103, v102 op_sel:[0,0] op_sel_hi:[1,0]
ds_write_addtid_b32 v94 offset:14960
v_pk_fma_f16 v95, v87, v99, v95 op_sel:[1,1,0] op_sel_hi:[0,1,1] neg_hi:[1,0,0]
v_pk_fma_f16 v106, v103, v102, v106 op_sel:[1,1,0] op_sel_hi:[0,1,1] neg_lo:[1,0,0]
v_pk_mul_f16 v128, v66, v100 op_sel:[0,0] op_sel_hi:[1,0]
v_pk_mul_f16 v129, v72, v103 op_sel:[0,0] op_sel_hi:[1,0]
ds_write_addtid_b32 v96 offset:4080
v_pk_fma_f16 v128, v66, v100, v128 op_sel:[1,1,0] op_sel_hi:[0,1,1] neg_lo:[1,0,0]
v_pk_fma_f16 v129, v72, v103, v129 op_sel:[1,1,0] op_sel_hi:[0,1,1] neg_lo:[1,0,0]
ds_write_addtid_b32 v95 offset:15232
v_pk_mul_f16 v130, v68, v100 op_sel:[0,0] op_sel_hi:[1,0]
v_pk_mul_f16 v131, v96, v103 op_sel:[0,0] op_sel_hi:[1,0]
ds_write_addtid_b32 v128 offset:4352
v_pk_fma_f16 v130, v68, v100, v130 op_sel:[1,1,0] op_sel_hi:[0,1,1] neg_lo:[1,0,0]
v_pk_fma_f16 v131, v96, v103, v131 op_sel:[1,1,0] op_sel_hi:[0,1,1] neg_lo:[1,0,0]
ds_write_addtid_b32 v129 offset:8704
v_pk_mul_f16 v128, v70, v100 op_sel:[0,0] op_sel_hi:[1,0]
v_pk_mul_f16 v129, v72, v104 op_sel:[0,0] op_sel_hi:[1,0]
ds_write_addtid_b32 v130 offset:4624
v_pk_fma_f16 v128, v70, v100, v128 op_sel:[1,1,0] op_sel_hi:[0,1,1] neg_lo:[1,0,0]
v_pk_fma_f16 v129, v72, v104, v129 op_sel:[1,1,0] op_sel_hi:[0,1,1] neg_lo:[1,0,0]
ds_write_addtid_b32 v131 offset:8976
v_pk_mul_f16 v130, v72, v100 op_sel:[0,0] op_sel_hi:[1,0]
v_pk_mul_f16 v131, v96, v104 op_sel:[0,0] op_sel_hi:[1,0]
ds_write_addtid_b32 v128 offset:4896
v_pk_fma_f16 v130, v72, v100, v130 op_sel:[1,1,0] op_sel_hi:[0,1,1] neg_lo:[1,0,0]
v_pk_fma_f16 v131, v96, v104, v131 op_sel:[1,1,0] op_sel_hi:[0,1,1] neg_lo:[1,0,0]
ds_write_addtid_b32 v129 offset:9248
v_pk_mul_f16 v128, v74, v100 op_sel:[0,0] op_sel_hi:[1,0]
v_pk_mul_f16 v129, v72, v105 op_sel:[0,0] op_sel_hi:[1,0]
ds_write_addtid_b32 v130 offset:5168
v_pk_fma_f16 v128, v74, v100, v128 op_sel:[1,1,0] op_sel_hi:[0,1,1] neg_lo:[1,0,0]
v_pk_fma_f16 v129, v72, v105, v129 op_sel:[1,1,0] op_sel_hi:[0,1,1] neg_lo:[1,0,0]
ds_write_addtid_b32 v131 offset:9520
v_pk_mul_f16 v130, v76, v100 op_sel:[0,0] op_sel_hi:[1,0]
v_pk_mul_f16 v131, v96, v105 op_sel:[0,0] op_sel_hi:[1,0]
ds_write_addtid_b32 v128 offset:5440
v_pk_fma_f16 v130, v76, v100, v130 op_sel:[1,1,0] op_sel_hi:[0,1,1] neg_lo:[1,0,0]
v_pk_fma_f16 v131, v96, v105, v131 op_sel:[1,1,0] op_sel_hi:[0,1,1] neg_lo:[1,0,0]
ds_write_addtid_b32 v129 offset:9792
v_pk_mul_f16 v128, v78, v100 op_sel:[0,0] op_sel_hi:[1,0]
v_pk_mul_f16 v129, v72, v106 op_sel:[0,0] op_sel_hi:[1,0]
ds_write_addtid_b32 v130 offset:5712
v_pk_fma_f16 v128, v78, v100, v128 op_sel:[1,1,0] op_sel_hi:[0,1,1] neg_lo:[1,0,0]
v_pk_fma_f16 v129, v72, v106, v129 op_sel:[1,1,0] op_sel_hi:[0,1,1] neg_lo:[1,0,0]
ds_write_addtid_b32 v131 offset:10064
v_pk_mul_f16 v130, v96, v100 op_sel:[0,0] op_sel_hi:[1,0]
v_pk_mul_f16 v131, v96, v106 op_sel:[0,0] op_sel_hi:[1,0]
ds_write_addtid_b32 v128 offset:5984
v_pk_fma_f16 v130, v96, v100, v130 op_sel:[1,1,0] op_sel_hi:[0,1,1] neg_lo:[1,0,0]
v_pk_fma_f16 v131, v96, v106, v131 op_sel:[1,1,0] op_sel_hi:[0,1,1] neg_lo:[1,0,0]
ds_write_addtid_b32 v129 offset:10336
v_pk_mul_f16 v128, v68, v101 op_sel:[0,0] op_sel_hi:[1,0]
ds_write_addtid_b32 v130 offset:6256
v_pk_fma_f16 v128, v68, v101, v128 op_sel:[1,1,0] op_sel_hi:[0,1,1] neg_lo:[1,0,0]
ds_write_addtid_b32 v131 offset:10608
v_pk_mul_f16 v130, v72, v101 op_sel:[0,0] op_sel_hi:[1,0]
ds_write_addtid_b32 v128 offset:6528
v_pk_fma_f16 v130, v72, v101, v130 op_sel:[1,1,0] op_sel_hi:[0,1,1] neg_lo:[1,0,0]
ds_write_addtid_b32 v64 offset:10880
v_pk_mul_f16 v128, v76, v101 op_sel:[0,0] op_sel_hi:[1,0]
ds_write_addtid_b32 v130 offset:6800
v_pk_fma_f16 v128, v76, v101, v128 op_sel:[1,1,0] op_sel_hi:[0,1,1] neg_lo:[1,0,0]
v_pk_mul_f16 v130, v96, v101 op_sel:[0,0] op_sel_hi:[1,0]
ds_write_addtid_b32 v128 offset:7072
v_pk_fma_f16 v130, v96, v101, v130 op_sel:[1,1,0] op_sel_hi:[0,1,1] neg_lo:[1,0,0]
v_pk_mul_f16 v128, v68, v102 op_sel:[0,0] op_sel_hi:[1,0]
ds_write_addtid_b32 v130 offset:7344
v_pk_fma_f16 v128, v68, v102, v128 op_sel:[1,1,0] op_sel_hi:[0,1,1] neg_lo:[1,0,0]
v_pk_mul_f16 v130, v72, v102 op_sel:[0,0] op_sel_hi:[1,0]
ds_write_addtid_b32 v128 offset:7616
v_pk_fma_f16 v130, v72, v102, v130 op_sel:[1,1,0] op_sel_hi:[0,1,1] neg_lo:[1,0,0]
v_pk_mul_f16 v128, v76, v102 op_sel:[0,0] op_sel_hi:[1,0]
ds_write_addtid_b32 v130 offset:7888
v_pk_fma_f16 v128, v76, v102, v128 op_sel:[1,1,0] op_sel_hi:[0,1,1] neg_lo:[1,0,0]
v_pk_mul_f16 v130, v96, v102 op_sel:[0,0] op_sel_hi:[1,0]
ds_write_addtid_b32 v128 offset:8160
v_pk_fma_f16 v130, v96, v102, v130 op_sel:[1,1,0] op_sel_hi:[0,1,1] neg_lo:[1,0,0]
ds_write_addtid_b32 v130 offset:8432
s_waitcnt lgkmcnt(6)
ds_read_b128 v[164:167], v42 offset:11152
ds_read_b128 v[152:155], v42 offset:0
ds_read_b128 v[156:159], v42 offset:4352
ds_read_b128 v[160:163], v42 offset:8704
ds_read_b128 v[180:183], v42 offset:11216
ds_read_b128 v[168:171], v42 offset:64
ds_read_b128 v[172:175], v42 offset:4416
ds_read_b128 v[176:179], v42 offset:8768
s_waitcnt lgkmcnt(6)
ds_read_b128 v[196:199], v42 offset:11280
ds_read_b128 v[184:187], v42 offset:128
ds_read_b128 v[188:191], v42 offset:4480
ds_read_b128 v[192:195], v42 offset:8832
ds_read_b128 v[212:215], v42 offset:11344
ds_read_b128 v[200:203], v42 offset:192
ds_read_b128 v[204:207], v42 offset:4544
ds_read_b128 v[208:211], v42 offset:8896
v_mul_f32 v120, 0x3f800000, v20
v_mul_f32 v122, 0x41800000, v20
v_mul_f32 v124, 0x43800000, v20
v_mul_f32 v121, 0x3f800000, v21
v_mul_f32 v123, 0x41800000, v21
v_mul_f32 v125, 0x43800000, v21
v_exp_f32 v120, v120
v_exp_f32 v122, v122
v_exp_f32 v124, v124
v_fract_f32 v121, v121
v_fract_f32 v123, v123
v_fract_f32 v125, v125
v_cos_f32 v108, v121
v_cos_f32 v110, v123
v_cos_f32 v112, v125
v_sin_f32 v109, v121
v_sin_f32 v111, v123
v_sin_f32 v113, v125
v_mul_f32 v108, v108, v120
v_mul_f32 v109, v109, v120
v_mul_f32 v110, v110, v122
v_mul_f32 v111, v111, v122
v_mul_f32 v112, v112, v124
v_mul_f32 v113, v113, v124
s_waitcnt lgkmcnt(0)
s_setprio 3
v_mfma_f32_16x16x32_f16 v[52:55], v[152:155], v[164:167], v[52:55]
v_mfma_f32_16x16x32_f16 v[56:59], v[156:159], v[164:167], v[56:59]
v_mfma_f32_16x16x32_f16 v[60:63], v[160:163], v[164:167], v[60:63]
v_mfma_f32_16x16x32_f16 v[52:55], v[168:171], v[180:183], v[52:55]
v_mfma_f32_16x16x32_f16 v[56:59], v[172:175], v[180:183], v[56:59]
v_mfma_f32_16x16x32_f16 v[60:63], v[176:179], v[180:183], v[60:63]
v_mfma_f32_16x16x32_f16 v[52:55], v[184:187], v[196:199], v[52:55]
v_mfma_f32_16x16x32_f16 v[56:59], v[188:191], v[196:199], v[56:59]
v_mfma_f32_16x16x32_f16 v[60:63], v[192:195], v[196:199], v[60:63]
v_mfma_f32_16x16x32_f16 v[52:55], v[200:203], v[212:215], v[52:55]
v_mfma_f32_16x16x32_f16 v[56:59], v[204:207], v[212:215], v[56:59]
v_mfma_f32_16x16x32_f16 v[60:63], v[208:211], v[212:215], v[60:63]
s_setprio 0
v_cvt_pk_f16_f32 v65, v108, v109
v_cvt_pk_f16_f32 v96, v110, v111
v_cvt_pk_f16_f32 v100, v112, v113
v_mul_f32 v120, v109, v109
v_add_f32 v121, v108, v108
v_mul_f32 v122, v111, v111
v_add_f32 v123, v110, v110
v_mul_f32 v124, v113, v113
v_add_f32 v125, v112, v112
v_fma_f32 v108, v108, v108, -v120
v_mul_f32 v109, v109, v121
v_fma_f32 v110, v110, v110, -v122
v_mul_f32 v111, v111, v123
v_fma_f32 v112, v112, v112, -v124
v_mul_f32 v113, v113, v125
v_cvt_pk_f16_f32 v66, v108, v109
v_cvt_pk_f16_f32 v97, v110, v111
v_cvt_pk_f16_f32 v101, v112, v113
v_mul_f32 v120, v109, v109
v_add_f32 v121, v108, v108
v_mul_f32 v122, v111, v111
v_add_f32 v123, v110, v110
v_mul_f32 v124, v113, v113
v_add_f32 v125, v112, v112
v_fma_f32 v108, v108, v108, -v120
v_mul_f32 v109, v109, v121
v_fma_f32 v110, v110, v110, -v122
v_mul_f32 v111, v111, v123
v_fma_f32 v112, v112, v112, -v124
v_mul_f32 v113, v113, v125
v_cvt_pk_f16_f32 v68, v108, v109
v_cvt_pk_f16_f32 v98, v110, v111
v_cvt_pk_f16_f32 v103, v112, v113
v_mul_f32 v120, v109, v109
v_add_f32 v121, v108, v108
v_mul_f32 v122, v111, v111
v_add_f32 v123, v110, v110
v_fma_f32 v108, v108, v108, -v120
v_mul_f32 v109, v109, v121
v_fma_f32 v110, v110, v110, -v122
v_mul_f32 v111, v111, v123
v_cvt_pk_f16_f32 v72, v108, v109
v_cvt_pk_f16_f32 v99, v110, v111
v_pk_mul_f16 v81, v22, v96 op_sel:[0,0] op_sel_hi:[1,0]
v_pk_fma_f16 v81, v22, v96, v81 op_sel:[1,1,0] op_sel_hi:[0,1,1] neg_hi:[1,0,0]
v_pk_mul_f16 v67, v65, v66 op_sel:[0,0] op_sel_hi:[1,0]
v_pk_mul_f16 v82, v22, v97 op_sel:[0,0] op_sel_hi:[1,0]
v_pk_fma_f16 v67, v65, v66, v67 op_sel:[1,1,0] op_sel_hi:[0,1,1] neg_lo:[1,0,0]
v_pk_fma_f16 v82, v22, v97, v82 op_sel:[1,1,0] op_sel_hi:[0,1,1] neg_hi:[1,0,0]
v_pk_mul_f16 v83, v81, v97 op_sel:[0,0] op_sel_hi:[1,0]
v_pk_mul_f16 v102, v101, v100 op_sel:[0,0] op_sel_hi:[1,0]
v_pk_fma_f16 v83, v81, v97, v83 op_sel:[1,1,0] op_sel_hi:[0,1,1] neg_hi:[1,0,0]
v_pk_fma_f16 v102, v101, v100, v102 op_sel:[1,1,0] op_sel_hi:[0,1,1] neg_lo:[1,0,0]
v_pk_mul_f16 v69, v65, v68 op_sel:[0,0] op_sel_hi:[1,0]
v_pk_mul_f16 v84, v22, v98 op_sel:[0,0] op_sel_hi:[1,0]
v_pk_fma_f16 v69, v65, v68, v69 op_sel:[1,1,0] op_sel_hi:[0,1,1] neg_lo:[1,0,0]
v_pk_fma_f16 v84, v22, v98, v84 op_sel:[1,1,0] op_sel_hi:[0,1,1] neg_hi:[1,0,0]
v_pk_mul_f16 v70, v66, v68 op_sel:[0,0] op_sel_hi:[1,0]
v_pk_mul_f16 v85, v81, v98 op_sel:[0,0] op_sel_hi:[1,0]
v_pk_mul_f16 v104, v103, v100 op_sel:[0,0] op_sel_hi:[1,0]
v_pk_fma_f16 v70, v66, v68, v70 op_sel:[1,1,0] op_sel_hi:[0,1,1] neg_lo:[1,0,0]
v_pk_fma_f16 v85, v81, v98, v85 op_sel:[1,1,0] op_sel_hi:[0,1,1] neg_hi:[1,0,0]
v_pk_fma_f16 v104, v103, v100, v104 op_sel:[1,1,0] op_sel_hi:[0,1,1] neg_lo:[1,0,0]
v_pk_mul_f16 v71, v67, v68 op_sel:[0,0] op_sel_hi:[1,0]
v_pk_mul_f16 v86, v82, v98 op_sel:[0,0] op_sel_hi:[1,0]
v_pk_fma_f16 v71, v67, v68, v71 op_sel:[1,1,0] op_sel_hi:[0,1,1] neg_lo:[1,0,0]
v_pk_fma_f16 v86, v82, v98, v86 op_sel:[1,1,0] op_sel_hi:[0,1,1] neg_hi:[1,0,0]
v_pk_mul_f16 v87, v83, v98 op_sel:[0,0] op_sel_hi:[1,0]
v_pk_mul_f16 v105, v103, v101 op_sel:[0,0] op_sel_hi:[1,0]
v_pk_fma_f16 v87, v83, v98, v87 op_sel:[1,1,0] op_sel_hi:[0,1,1] neg_hi:[1,0,0]
v_pk_fma_f16 v105, v103, v101, v105 op_sel:[1,1,0] op_sel_hi:[0,1,1] neg_lo:[1,0,0]
v_pk_mul_f16 v73, v65, v72 op_sel:[0,0] op_sel_hi:[1,0]
v_pk_mul_f16 v88, v22, v99 op_sel:[0,0] op_sel_hi:[1,0]
v_pk_fma_f16 v73, v65, v72, v73 op_sel:[1,1,0] op_sel_hi:[0,1,1] neg_lo:[1,0,0]
v_pk_fma_f16 v88, v22, v99, v88 op_sel:[1,1,0] op_sel_hi:[0,1,1] neg_hi:[1,0,0]
v_pk_mul_f16 v74, v66, v72 op_sel:[0,0] op_sel_hi:[1,0]
v_pk_mul_f16 v89, v81, v99 op_sel:[0,0] op_sel_hi:[1,0]
v_pk_fma_f16 v74, v66, v72, v74 op_sel:[1,1,0] op_sel_hi:[0,1,1] neg_lo:[1,0,0]
v_pk_fma_f16 v89, v81, v99, v89 op_sel:[1,1,0] op_sel_hi:[0,1,1] neg_hi:[1,0,0]
v_pk_mul_f16 v75, v67, v72 op_sel:[0,0] op_sel_hi:[1,0]
v_pk_mul_f16 v90, v82, v99 op_sel:[0,0] op_sel_hi:[1,0]
v_pk_fma_f16 v75, v67, v72, v75 op_sel:[1,1,0] op_sel_hi:[0,1,1] neg_lo:[1,0,0]
v_pk_fma_f16 v90, v82, v99, v90 op_sel:[1,1,0] op_sel_hi:[0,1,1] neg_hi:[1,0,0]
v_pk_mul_f16 v76, v68, v72 op_sel:[0,0] op_sel_hi:[1,0]
v_pk_mul_f16 v91, v83, v99 op_sel:[0,0] op_sel_hi:[1,0]
v_pk_fma_f16 v76, v68, v72, v76 op_sel:[1,1,0] op_sel_hi:[0,1,1] neg_lo:[1,0,0]
v_pk_fma_f16 v91, v83, v99, v91 op_sel:[1,1,0] op_sel_hi:[0,1,1] neg_hi:[1,0,0]
v_pk_mul_f16 v77, v69, v72 op_sel:[0,0] op_sel_hi:[1,0]
v_pk_mul_f16 v92, v84, v99 op_sel:[0,0] op_sel_hi:[1,0]
v_pk_fma_f16 v77, v69, v72, v77 op_sel:[1,1,0] op_sel_hi:[0,1,1] neg_lo:[1,0,0]
v_pk_fma_f16 v92, v84, v99, v92 op_sel:[1,1,0] op_sel_hi:[0,1,1] neg_hi:[1,0,0]
v_pk_mul_f16 v78, v70, v72 op_sel:[0,0] op_sel_hi:[1,0]
v_pk_mul_f16 v93, v85, v99 op_sel:[0,0] op_sel_hi:[1,0]
v_pk_fma_f16 v78, v70, v72, v78 op_sel:[1,1,0] op_sel_hi:[0,1,1] neg_lo:[1,0,0]
v_pk_fma_f16 v93, v85, v99, v93 op_sel:[1,1,0] op_sel_hi:[0,1,1] neg_hi:[1,0,0]
v_pk_mul_f16 v79, v71, v72 op_sel:[0,0] op_sel_hi:[1,0]
v_pk_mul_f16 v94, v86, v99 op_sel:[0,0] op_sel_hi:[1,0]
v_pk_fma_f16 v79, v71, v72, v79 op_sel:[1,1,0] op_sel_hi:[0,1,1] neg_lo:[1,0,0]
v_pk_fma_f16 v94, v86, v99, v94 op_sel:[1,1,0] op_sel_hi:[0,1,1] neg_hi:[1,0,0]
v_pk_mul_f16 v95, v87, v99 op_sel:[0,0] op_sel_hi:[1,0]
v_pk_mul_f16 v106, v103, v102 op_sel:[0,0] op_sel_hi:[1,0]
v_pk_fma_f16 v95, v87, v99, v95 op_sel:[1,1,0] op_sel_hi:[0,1,1] neg_hi:[1,0,0]
v_pk_fma_f16 v106, v103, v102, v106 op_sel:[1,1,0] op_sel_hi:[0,1,1] neg_lo:[1,0,0]
v_pk_mul_f16 v152, v66, v100 op_sel:[0,0] op_sel_hi:[1,0]
v_pk_mul_f16 v153, v72, v103 op_sel:[0,0] op_sel_hi:[1,0]
v_pk_fma_f16 v152, v66, v100, v152 op_sel:[1,1,0] op_sel_hi:[0,1,1] neg_lo:[1,0,0]
v_pk_fma_f16 v153, v72, v103, v153 op_sel:[1,1,0] op_sel_hi:[0,1,1] neg_lo:[1,0,0]
v_pk_mul_f16 v154, v68, v100 op_sel:[0,0] op_sel_hi:[1,0]
v_pk_mul_f16 v155, v96, v103 op_sel:[0,0] op_sel_hi:[1,0]
v_pk_fma_f16 v154, v68, v100, v154 op_sel:[1,1,0] op_sel_hi:[0,1,1] neg_lo:[1,0,0]
v_pk_fma_f16 v155, v96, v103, v155 op_sel:[1,1,0] op_sel_hi:[0,1,1] neg_lo:[1,0,0]
v_pk_mul_f16 v156, v70, v100 op_sel:[0,0] op_sel_hi:[1,0]
v_pk_mul_f16 v157, v72, v104 op_sel:[0,0] op_sel_hi:[1,0]
v_pk_fma_f16 v156, v70, v100, v156 op_sel:[1,1,0] op_sel_hi:[0,1,1] neg_lo:[1,0,0]
v_pk_fma_f16 v157, v72, v104, v157 op_sel:[1,1,0] op_sel_hi:[0,1,1] neg_lo:[1,0,0]
v_pk_mul_f16 v158, v72, v100 op_sel:[0,0] op_sel_hi:[1,0]
v_pk_mul_f16 v159, v96, v104 op_sel:[0,0] op_sel_hi:[1,0]
v_pk_fma_f16 v158, v72, v100, v158 op_sel:[1,1,0] op_sel_hi:[0,1,1] neg_lo:[1,0,0]
v_pk_fma_f16 v159, v96, v104, v159 op_sel:[1,1,0] op_sel_hi:[0,1,1] neg_lo:[1,0,0]
v_pk_mul_f16 v160, v74, v100 op_sel:[0,0] op_sel_hi:[1,0]
v_pk_mul_f16 v161, v72, v105 op_sel:[0,0] op_sel_hi:[1,0]
v_pk_fma_f16 v160, v74, v100, v160 op_sel:[1,1,0] op_sel_hi:[0,1,1] neg_lo:[1,0,0]
v_pk_fma_f16 v161, v72, v105, v161 op_sel:[1,1,0] op_sel_hi:[0,1,1] neg_lo:[1,0,0]
v_pk_mul_f16 v162, v76, v100 op_sel:[0,0] op_sel_hi:[1,0]
v_pk_mul_f16 v163, v96, v105 op_sel:[0,0] op_sel_hi:[1,0]
v_pk_fma_f16 v162, v76, v100, v162 op_sel:[1,1,0] op_sel_hi:[0,1,1] neg_lo:[1,0,0]
v_pk_fma_f16 v163, v96, v105, v163 op_sel:[1,1,0] op_sel_hi:[0,1,1] neg_lo:[1,0,0]
v_pk_mul_f16 v164, v78, v100 op_sel:[0,0] op_sel_hi:[1,0]
v_pk_mul_f16 v165, v72, v106 op_sel:[0,0] op_sel_hi:[1,0]
v_pk_fma_f16 v164, v78, v100, v164 op_sel:[1,1,0] op_sel_hi:[0,1,1] neg_lo:[1,0,0]
v_pk_fma_f16 v165, v72, v106, v165 op_sel:[1,1,0] op_sel_hi:[0,1,1] neg_lo:[1,0,0]
v_pk_mul_f16 v166, v96, v100 op_sel:[0,0] op_sel_hi:[1,0]
v_pk_mul_f16 v167, v96, v106 op_sel:[0,0] op_sel_hi:[1,0]
v_pk_fma_f16 v166, v96, v100, v166 op_sel:[1,1,0] op_sel_hi:[0,1,1] neg_lo:[1,0,0]
v_pk_fma_f16 v167, v96, v106, v167 op_sel:[1,1,0] op_sel_hi:[0,1,1] neg_lo:[1,0,0]
v_pk_mul_f16 v168, v68, v101 op_sel:[0,0] op_sel_hi:[1,0]
v_pk_fma_f16 v168, v68, v101, v168 op_sel:[1,1,0] op_sel_hi:[0,1,1] neg_lo:[1,0,0]
v_pk_mul_f16 v170, v72, v101 op_sel:[0,0] op_sel_hi:[1,0]
v_pk_fma_f16 v170, v72, v101, v170 op_sel:[1,1,0] op_sel_hi:[0,1,1] neg_lo:[1,0,0]
v_pk_mul_f16 v172, v76, v101 op_sel:[0,0] op_sel_hi:[1,0]
v_pk_fma_f16 v172, v76, v101, v172 op_sel:[1,1,0] op_sel_hi:[0,1,1] neg_lo:[1,0,0]
v_pk_mul_f16 v174, v96, v101 op_sel:[0,0] op_sel_hi:[1,0]
v_pk_fma_f16 v174, v96, v101, v174 op_sel:[1,1,0] op_sel_hi:[0,1,1] neg_lo:[1,0,0]
v_pk_mul_f16 v176, v68, v102 op_sel:[0,0] op_sel_hi:[1,0]
v_pk_fma_f16 v176, v68, v102, v176 op_sel:[1,1,0] op_sel_hi:[0,1,1] neg_lo:[1,0,0]
v_pk_mul_f16 v178, v72, v102 op_sel:[0,0] op_sel_hi:[1,0]
v_pk_fma_f16 v178, v72, v102, v178 op_sel:[1,1,0] op_sel_hi:[0,1,1] neg_lo:[1,0,0]
v_pk_mul_f16 v180, v76, v102 op_sel:[0,0] op_sel_hi:[1,0]
v_pk_fma_f16 v180, v76, v102, v180 op_sel:[1,1,0] op_sel_hi:[0,1,1] neg_lo:[1,0,0]
v_pk_mul_f16 v182, v96, v102 op_sel:[0,0] op_sel_hi:[1,0]
v_pk_fma_f16 v182, v96, v102, v182 op_sel:[1,1,0] op_sel_hi:[0,1,1] neg_lo:[1,0,0]
v_fma_f32 v108, v136, v132, v137
v_fma_f32 v112, v136, v133, v137
v_fma_f32 v116, v136, v135, v137
v_mul_f32 v6, v136, v134
v_fmamk_f32 v109, v136, 0x3f800000, v108
v_fmamk_f32 v113, v6, 0x3f800000, v112
v_fmamk_f32 v117, v136, 0x41000000, v116
v_fmamk_f32 v110, v136, 0x40000000, v108
v_fmamk_f32 v114, v6, 0x40000000, v112
v_fmamk_f32 v118, v136, 0x43800000, v116
v_fmamk_f32 v111, v136, 0x40400000, v108
v_fmamk_f32 v115, v6, 0x40400000, v112
v_fmamk_f32 v119, v136, 0x43840000, v116
v_exp_f32 v108, v108
v_exp_f32 v109, v109
v_exp_f32 v110, v110
v_exp_f32 v111, v111
v_exp_f32 v112, v112
v_exp_f32 v113, v113
v_exp_f32 v114, v114
v_exp_f32 v115, v115
v_exp_f32 v116, v116
v_exp_f32 v117, v117
v_exp_f32 v118, v118
v_exp_f32 v119, v119
v_mul_f32 v108, v3, v108
v_mul_f32 v109, v3, v109
v_mul_f32 v110, v3, v110
v_mul_f32 v111, v3, v111
v_mul_f32 v112, v3, v112
v_mul_f32 v113, v3, v113
v_mul_f32 v114, v3, v114
v_mul_f32 v115, v3, v115
v_mul_f32 v116, v3, v116
v_mul_f32 v117, v3, v117
v_mul_f32 v118, v3, v118
v_mul_f32 v119, v3, v119
s_setprio 0
s_cmp_lg_u32 s24, 0
s_cbranch_scc1 L_u_ok
s_mov_b32 s42, 0
buffer_load_dword v253, v252, s[48:51], 0 offen offset:128 sc1
s_waitcnt vmcnt(0)
L_u_p:
v_cmp_ne_u32 vcc, 1, v253
s_cbranch_vccz L_u_ok
s_add_u32 s42, s42, 1
s_cmp_gt_u32 s42, 20000
s_cbranch_scc1 L_u_ok
s_sleep 32
buffer_load_dword v253, v252, s[48:51], 0 offen offset:128 sc1
s_waitcnt vmcnt(0)
s_branch L_u_p
L_u_ok:
s_barrier
s_add_u32 m0, s37, 65536
s_nop 0
buffer_load_dwordx4 v1, s[20:23], s38 offen offset:0 sc1 lds
buffer_load_dwordx4 v1, s[20:23], s38 offen offset:1024 sc1 lds
buffer_load_dwordx4 v1, s[20:23], s38 offen offset:2048 sc1 lds
buffer_load_dwordx4 v1, s[20:23], s38 offen offset:3072 sc1 lds
s_mov_b32 m0, s28
s_cmp_lg_u32 s24, 0
s_cbranch_scc1 L_go_ok
s_lshl_b32 s33, s25, 7
s_add_u32 s33, s33, 14897152
v_mov_b32 v252, s33
s_mov_b32 s42, 0
buffer_load_dword v253, v252, s[20:23], 0 offen sc1
s_waitcnt vmcnt(0)
L_go_p:
v_cmp_ne_u32 vcc, 1, v253
s_cbranch_vccz L_go_ok
s_add_u32 s42, s42, 1
s_cmp_gt_u32 s42, 24
s_cbranch_scc1 L_go_ok
s_sleep 8
buffer_load_dword v253, v252, s[20:23], 0 offen sc1
s_waitcnt vmcnt(0)
s_branch L_go_p
L_go_ok:
s_barrier
s_setprio 1
ds_write_addtid_b32 v65 offset:0
ds_write_addtid_b32 v22 offset:11152
ds_write_addtid_b32 v66 offset:272
ds_write_addtid_b32 v81 offset:11424
ds_write_addtid_b32 v67 offset:544
ds_write_addtid_b32 v82 offset:11696
s_waitcnt lgkmcnt(8)
ds_write_addtid_b32 v68 offset:816
ds_write_addtid_b32 v83 offset:11968
ds_write_addtid_b32 v69 offset:1088
ds_write_addtid_b32 v84 offset:12240
ds_write_addtid_b32 v70 offset:1360
ds_write_addtid_b32 v85 offset:12512
s_waitcnt lgkmcnt(8)
ds_write_addtid_b32 v71 offset:1632
ds_write_addtid_b32 v86 offset:12784
ds_write_addtid_b32 v72 offset:1904
ds_write_addtid_b32 v87 offset:13056
ds_write_addtid_b32 v73 offset:2176
ds_write_addtid_b32 v88 offset:13328
s_waitcnt lgkmcnt(8)
ds_write_addtid_b32 v74 offset:2448
ds_write_addtid_b32 v89 offset:13600
ds_write_addtid_b32 v75 offset:2720
ds_write_addtid_b32 v90 offset:13872
ds_write_addtid_b32 v76 offset:2992
ds_write_addtid_b32 v91 offset:14144
s_waitcnt lgkmcnt(8)
ds_write_addtid_b32 v77 offset:3264
ds_write_addtid_b32 v92 offset:14416
ds_write_addtid_b32 v78 offset:3536
ds_write_addtid_b32 v93 offset:14688
ds_write_addtid_b32 v79 offset:3808
ds_write_addtid_b32 v94 offset:14960
s_waitcnt lgkmcnt(8)
ds_write_addtid_b32 v96 offset:4080
ds_write_addtid_b32 v95 offset:15232
ds_write_addtid_b32 v152 offset:4352
ds_write_addtid_b32 v153 offset:8704
ds_write_addtid_b32 v154 offset:4624
ds_write_addtid_b32 v155 offset:8976
s_waitcnt lgkmcnt(8)
ds_write_addtid_b32 v156 offset:4896
ds_write_addtid_b32 v157 offset:9248
ds_write_addtid_b32 v158 offset:5168
ds_write_addtid_b32 v159 offset:9520
ds_write_addtid_b32 v160 offset:5440
ds_write_addtid_b32 v161 offset:9792
s_waitcnt lgkmcnt(8)
ds_write_addtid_b32 v162 offset:5712
ds_write_addtid_b32 v163 offset:10064
ds_write_addtid_b32 v164 offset:5984
ds_write_addtid_b32 v165 offset:10336
ds_write_addtid_b32 v166 offset:6256
ds_write_addtid_b32 v167 offset:10608
s_waitcnt lgkmcnt(8)
ds_write_addtid_b32 v168 offset:6528
ds_write_addtid_b32 v64 offset:10880
ds_write_addtid_b32 v170 offset:6800
ds_write_addtid_b32 v172 offset:7072
ds_write_addtid_b32 v174 offset:7344
ds_write_addtid_b32 v176 offset:7616
s_waitcnt lgkmcnt(8)
ds_write_addtid_b32 v178 offset:7888
ds_write_addtid_b32 v180 offset:8160
ds_write_addtid_b32 v182 offset:8432
s_waitcnt lgkmcnt(6)
ds_read_b128 v[164:167], v42 offset:11152
ds_read_b128 v[152:155], v42 offset:0
ds_read_b128 v[156:159], v42 offset:4352
ds_read_b128 v[160:163], v42 offset:8704
ds_read_b128 v[180:183], v42 offset:11216
ds_read_b128 v[168:171], v42 offset:64
ds_read_b128 v[172:175], v42 offset:4416
ds_read_b128 v[176:179], v42 offset:8768
s_waitcnt lgkmcnt(6)
ds_read_b128 v[196:199], v42 offset:11280
ds_read_b128 v[184:187], v42 offset:128
ds_read_b128 v[188:191], v42 offset:4480
ds_read_b128 v[192:195], v42 offset:8832
ds_read_b128 v[212:215], v42 offset:11344
ds_read_b128 v[200:203], v42 offset:192
ds_read_b128 v[204:207], v42 offset:4544
ds_read_b128 v[208:211], v42 offset:8896
v_lshlrev_b32 v5, 16, v5
v_mov_b32 v9, s28
v_add_u32 v24, s28, v1
v_mov_b32 v16, 0
v_mov_b32 v17, 0
v_mov_b32 v18, 0
v_mov_b32 v19, 0
s_waitcnt lgkmcnt(0)
s_setprio 3
v_mfma_f32_16x16x32_f16 v[52:55], v[152:155], v[164:167], v[52:55]
v_mfma_f32_16x16x32_f16 v[56:59], v[156:159], v[164:167], v[56:59]
v_mfma_f32_16x16x32_f16 v[60:63], v[160:163], v[164:167], v[60:63]
v_mfma_f32_16x16x32_f16 v[52:55], v[168:171], v[180:183], v[52:55]
v_mfma_f32_16x16x32_f16 v[56:59], v[172:175], v[180:183], v[56:59]
v_mfma_f32_16x16x32_f16 v[60:63], v[176:179], v[180:183], v[60:63]
v_mfma_f32_16x16x32_f16 v[52:55], v[184:187], v[196:199], v[52:55]
v_mfma_f32_16x16x32_f16 v[56:59], v[188:191], v[196:199], v[56:59]
v_mfma_f32_16x16x32_f16 v[60:63], v[192:195], v[196:199], v[60:63]
v_mfma_f32_16x16x32_f16 v[52:55], v[200:203], v[212:215], v[52:55]
v_mfma_f32_16x16x32_f16 v[56:59], v[204:207], v[212:215], v[56:59]
v_mfma_f32_16x16x32_f16 v[60:63], v[208:211], v[212:215], v[60:63]
s_setprio 1
ds_write_b128 v24, v[16:19] offset:0
ds_write_b128 v24, v[16:19] offset:1024
ds_write_b128 v24, v[16:19] offset:2048
ds_write_b128 v24, v[16:19] offset:3072
s_cmp_lg_u32 s24, 3
s_cbranch_scc1 L_nz
ds_write_b128 v24, v[16:19] offset:14336
ds_write_b128 v24, v[16:19] offset:15360
L_nz:
v_mul_f32 v52, v52, v108
v_mul_f32 v53, v53, v109
v_mul_f32 v54, v54, v110
v_mul_f32 v55, v55, v111
v_mul_f32 v56, v56, v112
v_mul_f32 v57, v57, v113
v_mul_f32 v58, v58, v114
v_mul_f32 v59, v59, v115
v_mul_f32 v60, v60, v116
v_mul_f32 v61, v61, v117
v_mul_f32 v62, v62, v118
v_mul_f32 v63, v63, v119
v_add_f32 v5, v5, v60
v_cvt_pk_bf16_f32 v5, 0, v5
v_cvt_pk_bf16_f32 v10, v52, v53
v_cvt_pk_bf16_f32 v11, v54, v55
v_cvt_pk_bf16_f32 v12, v56, v57
v_cvt_pk_bf16_f32 v13, v58, v59
v_cvt_pk_bf16_f32 v14, v60, v61
v_cvt_pk_bf16_f32 v15, v62, v63
ds_write_b64 v46, v[10:11] offset:8
ds_write_b64 v47, v[12:13]
ds_write2_b32 v48, v14, v15 offset0:0 offset1:16
v_cmp_eq_u32 vcc, 32, v0
s_nop 0
s_and_saveexec_b64 s[34:35], vcc
ds_write_b32 v9, v5 offset:4
s_mov_b64 exec, s[34:35]
s_waitcnt lgkmcnt(4)
ds_read_u16 v64, v140
ds_read_u16 v65, v141
ds_read_u16 v66, v142
ds_read_u16 v67, v143
ds_read_u16 v68, v144
ds_read_u16 v69, v145
ds_read_u16 v70, v146
ds_read_u16 v71, v147
ds_read_u16 v72, v148
ds_read_u16 v73, v9 offset:774
ds_read_u16 v74, v9 offset:1182
v_mov_b32 v5, v2
v_lshl_add_u32 v10, v4, 1, v5
v_subrev_u32 v10, 3, v10
s_mov_b32 s40, 65536
v_bfe_u32 v16, v10, 2, 2
v_xor_b32 v16, s24, v16
v_lshl_add_u32 v17, v10, 6, s40
v_lshl_add_u32 v14, v16, 4, v17
v_subrev_u32 v10, -1, v10
v_bfe_u32 v16, v10, 2, 2
v_xor_b32 v16, s24, v16
v_lshl_add_u32 v17, v10, 6, s40
v_lshl_add_u32 v15, v16, 4, v17
v_subrev_u32 v10, 4, v10
v_or_b32 v6, 1, v4
v_sub_u32 v6, 527, v6
v_lshlrev_b32 v6, 1, v6
v_lshl_add_u32 v6, v5, 4, v6
v_and_b32 v7, 1, v4
v_mul_u32_u24 v7, 1216, v7
v_sub_u32 v6, v6, v7
s_add_u32 s33, s28, 2240
v_add_u32 v11, s33, v6
v_subrev_u32 v18, 384, v11
v_lshlrev_b32 v6, 2, v5
v_sub_u32 v6, v4, v6
s_add_u32 s33, s28, 904
v_lshl_add_u32 v12, v6, 3, s33
s_add_u32 s33, s28, 1380
v_lshl_add_u32 v13, v6, 2, s33
s_waitcnt lgkmcnt(0)
v_lshl_or_b32 v80, v65, 16, v64
v_lshl_or_b32 v84, v66, 16, v65
v_lshl_or_b32 v81, v67, 16, v66
v_lshl_or_b32 v85, v68, 16, v67
v_lshl_or_b32 v82, v69, 16, v68
v_lshl_or_b32 v86, v70, 16, v69
v_lshl_or_b32 v83, v71, 16, v70
v_lshl_or_b32 v87, v72, 16, v71
ds_write_b128 v24, v[80:83] offset:1728
ds_write_b128 v24, v[84:87] offset:2944
v_lshlrev_b32 v88, 16, v73
v_or_b32 v89, v88, v73
v_mov_b32 v90, v89
v_mov_b32 v91, v89
ds_write_b64 v9, v[88:89] offset:1720
ds_write_b64 v9, v[90:91] offset:2936
v_lshl_or_b32 v6, v74, 16, v74
v_and_b32 v248, v6, v248
v_and_b32 v249, v6, v249
v_and_b32 v250, v6, v250
v_and_b32 v251, v6, v251
v_mov_b32 v32, 0
v_mov_b32 v33, 0
v_mov_b32 v34, 0
v_mov_b32 v35, 0
v_mov_b32 v36, 0
v_mov_b32 v37, 0
v_mov_b32 v38, 0
v_mov_b32 v39, 0
v_mov_b32 v40, 0
v_mov_b32 v41, 0
v_mov_b32 v42, 0
v_mov_b32 v43, 0
v_mov_b32 v44, 0
v_mov_b32 v45, 0
v_mov_b32 v46, 0
v_mov_b32 v47, 0
v_mov_b32 v48, 0
v_mov_b32 v49, 0
v_mov_b32 v50, 0
v_mov_b32 v51, 0
v_mov_b32 v52, 0
v_mov_b32 v53, 0
v_mov_b32 v54, 0
v_mov_b32 v55, 0
v_mov_b32 v56, 0
v_mov_b32 v57, 0
v_mov_b32 v58, 0
v_mov_b32 v59, 0
v_mov_b32 v60, 0
v_mov_b32 v61, 0
v_mov_b32 v62, 0
v_mov_b32 v63, 0
s_waitcnt lgkmcnt(0)
ds_read2_b32 v[96:97], v11 offset0:160 offset1:161
ds_read2_b32 v[98:99], v11 offset0:162 offset1:163
ds_read2_b32 v[100:101], v11 offset0:32 offset1:33
ds_read2_b32 v[102:103], v11 offset0:34 offset1:35
ds_read2_b32 v[144:145], v18 offset0:0 offset1:1
ds_read2_b32 v[146:147], v18 offset0:2 offset1:3
ds_read2_b64 v[148:151], v12 offset0:2 offset1:3
ds_read2_b64 v[152:155], v12 offset0:0 offset1:1
ds_read2_b64 v[156:159], v12 offset0:18 offset1:19
ds_read2_b64 v[160:163], v12 offset0:16 offset1:17
ds_read2_b64 v[164:167], v12 offset0:34 offset1:35
ds_read2_b64 v[168:171], v12 offset0:32 offset1:33
s_waitcnt lgkmcnt(6)
ds_read2_b32 v[172:173], v13 offset0:0 offset1:1
ds_read2_b32 v[174:175], v13 offset0:2 offset1:3
ds_read2_b32 v[176:177], v13 offset0:16 offset1:17
ds_read2_b32 v[178:179], v13 offset0:18 offset1:19
ds_read2_b32 v[180:181], v13 offset0:32 offset1:33
ds_read2_b32 v[182:183], v13 offset0:34 offset1:35
ds_read2_b32 v[184:185], v13 offset0:48 offset1:49
ds_read2_b32 v[186:187], v13 offset0:50 offset1:51
s_waitcnt vmcnt(0) lgkmcnt(0)
s_barrier
ds_read_b128 v[64:67], v15 offset:0
ds_read_b128 v[68:71], v15 offset:2048
ds_read_b128 v[72:75], v15 offset:4096
ds_read_b128 v[76:79], v15 offset:6144
ds_read_b128 v[80:83], v15 offset:8192
ds_read_b128 v[84:87], v15 offset:10240
ds_read_b128 v[88:91], v15 offset:12288
ds_read_b128 v[92:95], v15 offset:14336
ds_read_b128 v[104:107], v14 offset:0
ds_read_b128 v[108:111], v14 offset:2048
ds_read_b128 v[112:115], v14 offset:4096
ds_read_b128 v[116:119], v14 offset:6144
ds_read_b128 v[120:123], v14 offset:8192
ds_read_b128 v[124:127], v14 offset:10240
v_bfe_u32 v16, v10, 2, 2
v_xor_b32 v16, s24, v16
v_lshl_add_u32 v17, v10, 6, s40
v_lshl_add_u32 v15, v16, 4, v17
v_subrev_u32 v10, 4, v10
s_setprio 1
s_waitcnt lgkmcnt(0)
v_mfma_f32_16x16x32_bf16 v[188:191], v[64:67], v[232:235], 0
v_mfma_f32_16x16x32_bf16 v[192:195], v[64:67], v[236:239], 0
v_mfma_f32_16x16x32_bf16 v[196:199], v[104:107], v[232:235], 0
v_mfma_f32_16x16x32_bf16 v[200:203], v[104:107], v[236:239], 0
v_mfma_f32_16x16x32_bf16 v[204:207], v[64:67], v[240:243], 0
v_mfma_f32_16x16x32_bf16 v[208:211], v[104:107], v[244:247], 0
v_mfma_f32_16x16x32_bf16 v[40:43], v[144:147], v[64:67], v[40:43]
v_mfma_f32_16x16x32_bf16 v[44:47], v[144:147], v[68:71], v[44:47]
v_mfma_f32_16x16x32_bf16 v[48:51], v[144:147], v[72:75], v[48:51]
v_mfma_f32_16x16x32_bf16 v[52:55], v[144:147], v[76:79], v[52:55]
v_mfma_f32_16x16x32_bf16 v[128:131], v[68:71], v[232:235], 0
v_cvt_pk_bf16_f32 v20, v189, v193
v_cvt_pk_bf16_f32 v21, v197, v201
v_mfma_f32_16x16x32_bf16 v[132:135], v[68:71], v[236:239], 0
v_cvt_pk_bf16_f32 v22, v188, v192
v_cvt_pk_bf16_f32 v23, v196, v200
v_mfma_f32_16x16x32_bf16 v[136:139], v[108:111], v[232:235], 0
v_cvt_pk_bf16_f32 v24, v191, v195
v_cvt_pk_bf16_f32 v25, v199, v203
v_mfma_f32_16x16x32_bf16 v[140:143], v[108:111], v[236:239], 0
v_cvt_pk_bf16_f32 v26, v190, v194
v_cvt_pk_bf16_f32 v27, v198, v202
v_mfma_f32_16x16x32_bf16 v[212:215], v[68:71], v[240:243], 0
v_cvt_pk_bf16_f32 v28, v207, v211
v_cvt_pk_bf16_f32 v29, v206, v210
v_mfma_f32_16x16x32_bf16 v[216:219], v[108:111], v[244:247], 0
v_cvt_pk_bf16_f32 v30, v205, v209
v_cvt_pk_bf16_f32 v31, v204, v208
v_mfma_f32_16x16x32_bf16 v[56:59], v[144:147], v[80:83], v[56:59]
v_mfma_f32_16x16x32_bf16 v[60:63], v[144:147], v[84:87], v[60:63]
v_mfma_f32_16x16x32_bf16 v[40:43], v[20:23], v[148:151], v[40:43]
v_mfma_f32_16x16x32_bf16 v[40:43], v[24:27], v[152:155], v[40:43]
v_mfma_f32_16x16x32_bf16 v[44:47], v[20:23], v[156:159], v[44:47]
v_mfma_f32_16x16x32_bf16 v[44:47], v[24:27], v[160:163], v[44:47]
v_cvt_pk_bf16_f32 v220, v129, v133
v_cvt_pk_bf16_f32 v221, v137, v141
v_mfma_f32_16x16x32_bf16 v[48:51], v[20:23], v[164:167], v[48:51]
v_cvt_pk_bf16_f32 v222, v128, v132
v_cvt_pk_bf16_f32 v223, v136, v140
v_mfma_f32_16x16x32_bf16 v[48:51], v[24:27], v[168:171], v[48:51]
v_cvt_pk_bf16_f32 v224, v131, v135
v_cvt_pk_bf16_f32 v225, v139, v143
v_mfma_f32_16x16x32_bf16 v[48:51], v[28:31], v[172:175], v[48:51]
v_cvt_pk_bf16_f32 v226, v130, v134
v_cvt_pk_bf16_f32 v227, v138, v142
v_mfma_f32_16x16x32_bf16 v[52:55], v[28:31], v[176:179], v[52:55]
v_cvt_pk_bf16_f32 v228, v215, v219
v_cvt_pk_bf16_f32 v229, v214, v218
v_mfma_f32_16x16x32_bf16 v[56:59], v[28:31], v[180:183], v[56:59]
v_cvt_pk_bf16_f32 v230, v213, v217
v_cvt_pk_bf16_f32 v231, v212, v216
v_mfma_f32_16x16x32_bf16 v[60:63], v[28:31], v[184:187], v[60:63]
v_mfma_f32_16x16x32_bf16 v[188:191], v[72:75], v[232:235], 0
v_mfma_f32_16x16x32_bf16 v[192:195], v[72:75], v[236:239], 0
v_mfma_f32_16x16x32_bf16 v[196:199], v[112:115], v[232:235], 0
v_mfma_f32_16x16x32_bf16 v[200:203], v[112:115], v[236:239], 0
v_mfma_f32_16x16x32_bf16 v[204:207], v[72:75], v[240:243], 0
v_mfma_f32_16x16x32_bf16 v[208:211], v[112:115], v[244:247], 0
v_mfma_f32_16x16x32_bf16 v[44:47], v[220:223], v[148:151], v[44:47]
v_mfma_f32_16x16x32_bf16 v[44:47], v[224:227], v[152:155], v[44:47]
v_mfma_f32_16x16x32_bf16 v[48:51], v[220:223], v[156:159], v[48:51]
v_mfma_f32_16x16x32_bf16 v[48:51], v[224:227], v[160:163], v[48:51]
v_cvt_pk_bf16_f32 v20, v189, v193
s_nop 0
v_cvt_pk_bf16_f32 v21, v197, v201
v_mfma_f32_16x16x32_bf16 v[52:55], v[220:223], v[164:167], v[52:55]
v_cvt_pk_bf16_f32 v22, v188, v192
v_cvt_pk_bf16_f32 v23, v196, v200
v_mfma_f32_16x16x32_bf16 v[52:55], v[224:227], v[168:171], v[52:55]
v_cvt_pk_bf16_f32 v24, v191, v195
v_cvt_pk_bf16_f32 v25, v199, v203
v_mfma_f32_16x16x32_bf16 v[52:55], v[228:231], v[172:175], v[52:55]
v_cvt_pk_bf16_f32 v26, v190, v194
v_cvt_pk_bf16_f32 v27, v198, v202
v_mfma_f32_16x16x32_bf16 v[56:59], v[228:231], v[176:179], v[56:59]
v_cvt_pk_bf16_f32 v28, v207, v211
v_cvt_pk_bf16_f32 v29, v206, v210
v_mfma_f32_16x16x32_bf16 v[60:63], v[228:231], v[180:183], v[60:63]
v_cvt_pk_bf16_f32 v30, v205, v209
v_cvt_pk_bf16_f32 v31, v204, v208
v_mfma_f32_16x16x32_bf16 v[128:131], v[76:79], v[232:235], 0
v_mfma_f32_16x16x32_bf16 v[132:135], v[76:79], v[236:239], 0
v_mfma_f32_16x16x32_bf16 v[136:139], v[116:119], v[232:235], 0
v_mfma_f32_16x16x32_bf16 v[140:143], v[116:119], v[236:239], 0
v_mfma_f32_16x16x32_bf16 v[212:215], v[76:79], v[240:243], 0
v_mfma_f32_16x16x32_bf16 v[216:219], v[116:119], v[244:247], 0
v_mfma_f32_16x16x32_bf16 v[48:51], v[20:23], v[148:151], v[48:51]
v_mfma_f32_16x16x32_bf16 v[48:51], v[24:27], v[152:155], v[48:51]
v_mfma_f32_16x16x32_bf16 v[52:55], v[20:23], v[156:159], v[52:55]
v_mfma_f32_16x16x32_bf16 v[52:55], v[24:27], v[160:163], v[52:55]
v_cvt_pk_bf16_f32 v220, v129, v133
s_nop 0
v_cvt_pk_bf16_f32 v221, v137, v141
v_mfma_f32_16x16x32_bf16 v[56:59], v[20:23], v[164:167], v[56:59]
v_cvt_pk_bf16_f32 v222, v128, v132
v_cvt_pk_bf16_f32 v223, v136, v140
v_mfma_f32_16x16x32_bf16 v[56:59], v[24:27], v[168:171], v[56:59]
v_cvt_pk_bf16_f32 v224, v131, v135
v_cvt_pk_bf16_f32 v225, v139, v143
v_mfma_f32_16x16x32_bf16 v[56:59], v[28:31], v[172:175], v[56:59]
v_cvt_pk_bf16_f32 v226, v130, v134
v_cvt_pk_bf16_f32 v227, v138, v142
v_mfma_f32_16x16x32_bf16 v[60:63], v[28:31], v[176:179], v[60:63]
v_cvt_pk_bf16_f32 v228, v215, v219
v_cvt_pk_bf16_f32 v229, v214, v218
v_cvt_pk_bf16_f32 v230, v213, v217
v_cvt_pk_bf16_f32 v231, v212, v216
v_mfma_f32_16x16x32_bf16 v[188:191], v[80:83], v[232:235], 0
v_mfma_f32_16x16x32_bf16 v[192:195], v[80:83], v[236:239], 0
v_mfma_f32_16x16x32_bf16 v[196:199], v[120:123], v[232:235], 0
v_mfma_f32_16x16x32_bf16 v[200:203], v[120:123], v[236:239], 0
v_mfma_f32_16x16x32_bf16 v[52:55], v[220:223], v[148:151], v[52:55]
v_mfma_f32_16x16x32_bf16 v[52:55], v[224:227], v[152:155], v[52:55]
v_mfma_f32_16x16x32_bf16 v[56:59], v[220:223], v[156:159], v[56:59]
v_mfma_f32_16x16x32_bf16 v[56:59], v[224:227], v[160:163], v[56:59]
s_nop 1
v_cvt_pk_bf16_f32 v20, v189, v193
s_nop 0
v_cvt_pk_bf16_f32 v21, v197, v201
v_mfma_f32_16x16x32_bf16 v[60:63], v[220:223], v[164:167], v[60:63]
v_cvt_pk_bf16_f32 v22, v188, v192
v_cvt_pk_bf16_f32 v23, v196, v200
v_mfma_f32_16x16x32_bf16 v[60:63], v[224:227], v[168:171], v[60:63]
v_cvt_pk_bf16_f32 v24, v191, v195
v_cvt_pk_bf16_f32 v25, v199, v203
v_mfma_f32_16x16x32_bf16 v[60:63], v[228:231], v[172:175], v[60:63]
v_cvt_pk_bf16_f32 v26, v190, v194
v_cvt_pk_bf16_f32 v27, v198, v202
v_mfma_f32_16x16x32_bf16 v[128:131], v[84:87], v[232:235], 0
v_mfma_f32_16x16x32_bf16 v[132:135], v[84:87], v[236:239], 0
v_mfma_f32_16x16x32_bf16 v[136:139], v[124:127], v[232:235], 0
v_mfma_f32_16x16x32_bf16 v[140:143], v[124:127], v[236:239], 0
v_mfma_f32_16x16x32_bf16 v[56:59], v[20:23], v[148:151], v[56:59]
v_mfma_f32_16x16x32_bf16 v[56:59], v[24:27], v[152:155], v[56:59]
v_mfma_f32_16x16x32_bf16 v[60:63], v[20:23], v[156:159], v[60:63]
v_mfma_f32_16x16x32_bf16 v[60:63], v[24:27], v[160:163], v[60:63]
s_nop 1
v_cvt_pk_bf16_f32 v220, v129, v133
s_nop 0
v_cvt_pk_bf16_f32 v221, v137, v141
v_mfma_f32_16x16x32_bf16 v[48:51], v[248:251], v[64:67], v[48:51]
v_cvt_pk_bf16_f32 v222, v128, v132
v_cvt_pk_bf16_f32 v223, v136, v140
v_mfma_f32_16x16x32_bf16 v[52:55], v[248:251], v[68:71], v[52:55]
v_cvt_pk_bf16_f32 v224, v131, v135
v_cvt_pk_bf16_f32 v225, v139, v143
v_mfma_f32_16x16x32_bf16 v[56:59], v[248:251], v[72:75], v[56:59]
v_cvt_pk_bf16_f32 v226, v130, v134
v_cvt_pk_bf16_f32 v227, v138, v142
v_mfma_f32_16x16x32_bf16 v[60:63], v[248:251], v[76:79], v[60:63]
v_mfma_f32_16x16x32_bf16 v[60:63], v[220:223], v[148:151], v[60:63]
v_mfma_f32_16x16x32_bf16 v[60:63], v[224:227], v[152:155], v[60:63]
s_mov_b32 s54, 0
L_cv_loop:
s_waitcnt lgkmcnt(0)
v_mfma_f32_16x16x32_bf16 v[32:35], v[96:99], v[64:67], v[32:35]
ds_read2_b32 v[136:137], v11 offset0:144 offset1:145
v_mfma_f32_16x16x32_bf16 v[36:39], v[96:99], v[68:71], v[36:39]
ds_read2_b32 v[138:139], v11 offset0:146 offset1:147
v_mfma_f32_16x16x32_bf16 v[40:43], v[96:99], v[72:75], v[40:43]
ds_read2_b32 v[140:141], v11 offset0:16 offset1:17
v_mfma_f32_16x16x32_bf16 v[44:47], v[96:99], v[76:79], v[44:47]
ds_read2_b32 v[142:143], v11 offset0:18 offset1:19
v_mfma_f32_16x16x32_bf16 v[48:51], v[96:99], v[80:83], v[48:51]
ds_read_b128 v[104:107], v15 offset:0
v_mfma_f32_16x16x32_bf16 v[52:55], v[96:99], v[84:87], v[52:55]
ds_read_b128 v[108:111], v15 offset:2048
v_mfma_f32_16x16x32_bf16 v[56:59], v[96:99], v[88:91], v[56:59]
ds_read_b128 v[112:115], v15 offset:4096
v_mfma_f32_16x16x32_bf16 v[60:63], v[96:99], v[92:95], v[60:63]
ds_read_b128 v[116:119], v15 offset:6144
v_mfma_f32_16x16x32_bf16 v[36:39], v[100:103], v[64:67], v[36:39]
ds_read_b128 v[120:123], v15 offset:8192
v_mfma_f32_16x16x32_bf16 v[40:43], v[100:103], v[68:71], v[40:43]
ds_read_b128 v[124:127], v15 offset:10240
v_mfma_f32_16x16x32_bf16 v[44:47], v[100:103], v[72:75], v[44:47]
ds_read_b128 v[128:131], v15 offset:12288
v_mfma_f32_16x16x32_bf16 v[48:51], v[100:103], v[76:79], v[48:51]
ds_read_b128 v[132:135], v15 offset:14336
v_mfma_f32_16x16x32_bf16 v[52:55], v[100:103], v[80:83], v[52:55]
v_bfe_u32 v16, v10, 2, 2
v_xor_b32 v16, s24, v16
v_mfma_f32_16x16x32_bf16 v[56:59], v[100:103], v[84:87], v[56:59]
v_lshl_add_u32 v17, v10, 6, s40
v_lshl_add_u32 v15, v16, 4, v17
v_mfma_f32_16x16x32_bf16 v[60:63], v[100:103], v[88:91], v[60:63]
v_subrev_u32 v10, 4, v10
s_waitcnt lgkmcnt(0)
v_mfma_f32_16x16x32_bf16 v[32:35], v[136:139], v[104:107], v[32:35]
ds_read2_b32 v[96:97], v11 offset0:128 offset1:129
v_mfma_f32_16x16x32_bf16 v[36:39], v[136:139], v[108:111], v[36:39]
ds_read2_b32 v[98:99], v11 offset0:130 offset1:131
v_mfma_f32_16x16x32_bf16 v[40:43], v[136:139], v[112:115], v[40:43]
ds_read2_b32 v[100:101], v11 offset0:0 offset1:1
v_mfma_f32_16x16x32_bf16 v[44:47], v[136:139], v[116:119], v[44:47]
ds_read2_b32 v[102:103], v11 offset0:2 offset1:3
v_mfma_f32_16x16x32_bf16 v[48:51], v[136:139], v[120:123], v[48:51]
ds_read_b128 v[64:67], v15 offset:0
v_mfma_f32_16x16x32_bf16 v[52:55], v[136:139], v[124:127], v[52:55]
ds_read_b128 v[68:71], v15 offset:2048
v_mfma_f32_16x16x32_bf16 v[56:59], v[136:139], v[128:131], v[56:59]
ds_read_b128 v[72:75], v15 offset:4096
v_mfma_f32_16x16x32_bf16 v[60:63], v[136:139], v[132:135], v[60:63]
ds_read_b128 v[76:79], v15 offset:6144
v_mfma_f32_16x16x32_bf16 v[36:39], v[140:143], v[104:107], v[36:39]
ds_read_b128 v[80:83], v15 offset:8192
v_mfma_f32_16x16x32_bf16 v[40:43], v[140:143], v[108:111], v[40:43]
ds_read_b128 v[84:87], v15 offset:10240
v_mfma_f32_16x16x32_bf16 v[44:47], v[140:143], v[112:115], v[44:47]
ds_read_b128 v[88:91], v15 offset:12288
v_mfma_f32_16x16x32_bf16 v[48:51], v[140:143], v[116:119], v[48:51]
ds_read_b128 v[92:95], v15 offset:14336
v_mfma_f32_16x16x32_bf16 v[52:55], v[140:143], v[120:123], v[52:55]
v_bfe_u32 v16, v10, 2, 2
v_xor_b32 v16, s24, v16
v_mfma_f32_16x16x32_bf16 v[56:59], v[140:143], v[124:127], v[56:59]
v_lshl_add_u32 v17, v10, 6, s40
v_lshl_add_u32 v15, v16, 4, v17
v_mfma_f32_16x16x32_bf16 v[60:63], v[140:143], v[128:131], v[60:63]
v_subrev_u32 v10, 4, v10
v_subrev_u32 v11, 128, v11
s_add_u32 s54, s54, 1
s_cmp_lt_u32 s54, 4
s_cbranch_scc1 L_cv_loop
L_cv_skip:
s_mul_i32 s33, s24, 16448
s_add_u32 s33, s33, 9984
v_lshlrev_b32 v6, 3, v5
v_lshl_add_u32 v6, v4, 5, v6
v_add_u32 v6, s33, v6
s_waitcnt lgkmcnt(0)
v_cvt_pk_bf16_f32 v16, v32, v33
v_cvt_pk_bf16_f32 v17, v34, v35
ds_write_b64 v6, v[16:17] offset:0
v_cvt_pk_bf16_f32 v18, v36, v37
v_cvt_pk_bf16_f32 v19, v38, v39
ds_write_b64 v6, v[18:19] offset:512
v_cvt_pk_bf16_f32 v20, v40, v41
v_cvt_pk_bf16_f32 v21, v42, v43
ds_write_b64 v6, v[20:21] offset:1024
v_cvt_pk_bf16_f32 v22, v44, v45
v_cvt_pk_bf16_f32 v23, v46, v47
ds_write_b64 v6, v[22:23] offset:1536
v_cvt_pk_bf16_f32 v24, v48, v49
v_cvt_pk_bf16_f32 v25, v50, v51
ds_write_b64 v6, v[24:25] offset:2048
v_cvt_pk_bf16_f32 v26, v52, v53
v_cvt_pk_bf16_f32 v27, v54, v55
ds_write_b64 v6, v[26:27] offset:2560
v_cvt_pk_bf16_f32 v28, v56, v57
v_cvt_pk_bf16_f32 v29, v58, v59
ds_write_b64 v6, v[28:29] offset:3072
v_cvt_pk_bf16_f32 v30, v60, v61
v_cvt_pk_bf16_f32 v31, v62, v63
ds_write_b64 v6, v[30:31] offset:3584
v_lshrrev_b32 v6, 2, v0
v_and_b32 v6, 3, v6
v_mul_u32_u24 v6, 16448, v6
v_lshl_add_u32 v6, v5, 6, v6
v_and_b32 v7, 3, v0
v_lshl_add_u32 v6, v7, 3, v6
s_lshl_b32 s33, s24, 10
s_add_u32 s33, s33, 9984
v_add_u32 v6, s33, v6
s_waitcnt lgkmcnt(0)
s_barrier
ds_read_b64_tr_b16 v[32:33], v6 offset:0
ds_read_b64_tr_b16 v[34:35], v6 offset:32
ds_read_b64_tr_b16 v[36:37], v6 offset:256
ds_read_b64_tr_b16 v[38:39], v6 offset:288
ds_read_b64_tr_b16 v[40:41], v6 offset:512
ds_read_b64_tr_b16 v[42:43], v6 offset:544
ds_read_b64_tr_b16 v[44:45], v6 offset:768
ds_read_b64_tr_b16 v[46:47], v6 offset:800
s_waitcnt lgkmcnt(6)
buffer_store_dwordx4 v[32:35], v1, s[20:23], s39 offen offset:0 sc1
s_waitcnt lgkmcnt(4)
buffer_store_dwordx4 v[36:39], v1, s[20:23], s39 offen offset:1024 sc1
s_waitcnt lgkmcnt(2)
buffer_store_dwordx4 v[40:43], v1, s[20:23], s39 offen offset:2048 sc1
s_waitcnt lgkmcnt(0)
buffer_store_dwordx4 v[44:47], v1, s[20:23], s39 offen offset:3072 sc1
s_lshl_b32 s33, s25, 7
s_add_u32 s33, s33, 14876672
v_mov_b32 v6, s33
v_mov_b32 v7, 1
s_waitcnt vmcnt(0)
s_barrier
s_cmp_lg_u32 s24, 0
s_cbranch_scc1 L_kc_done
v_cmp_eq_u32 vcc, 0, v0
s_nop 0
s_and_saveexec_b64 s[34:35], vcc
buffer_store_dword v7, v6, s[20:23], 0 offen sc1
s_mov_b64 exec, s[34:35]
L_kc_done:
s_endpgm
L_end:
s_endpgm
L_code_end:
.section .rodata,"a"
.p2align 6
.amdhsa_kernel parallel_sum__ssm_conv_s4__swiglu_ffn__prompt_kernel
  .amdhsa_next_free_vgpr 256
  .amdhsa_next_free_sgpr 102
  .amdhsa_accum_offset 256
  .amdhsa_group_segment_fixed_size 0
  .amdhsa_kernarg_size 128
  .amdhsa_user_sgpr_count 2
  .amdhsa_user_sgpr_kernarg_segment_ptr 1
  .amdhsa_system_sgpr_workgroup_id_x 1
.end_amdhsa_kernel
```
